```python
import torch

def _softmax(x, axis=-1):
    return torch.softmax(x, dim=axis)
def _gelu(x):
    return torch.nn.functional.gelu(x, approximate="tanh")
def _silu(x):
    return torch.nn.functional.silu(x)
def _sigmoid(x):
    return torch.sigmoid(x)
def _layernorm(x, axis=-1, eps=1e-5):
    m = x.mean(dim=axis, keepdim=True)
    v = x.var(dim=axis, keepdim=True, unbiased=False)
    return (x - m) / torch.sqrt(v + eps)
def _scatter_add(tgt, idx, src, axis=0):
    return tgt.clone().index_add_(axis, idx, src)
def _segment_sum(src, seg, n):
    out = torch.zeros((n,) + src.shape[1:], dtype=src.dtype)
    return out.index_add_(0, seg, src)
def _pad(x, pw):
    flat = tuple(v for pair in reversed(pw) for v in pair)
    return torch.nn.functional.pad(x, flat)

kernel_name = 'concat_heads__sliding_block__sliding_block__prompt'

def setup_inputs():

    _w = (lambda a: (lambda t: t.to(torch.bfloat16) if t.is_floating_point() else t)(torch.as_tensor(a)))
    def _A_setup():
        B, S, D = 1, 2048, 512
        return {
            "x": _w((lambda *s: torch.randn(*s, dtype=torch.bfloat16) * 0.2)(B, S, D)),
            "wqkv": _w((lambda *s: torch.randn(*s, dtype=torch.bfloat16) * 0.4)(D, 3 * D)),
            "wo": _w((lambda *s: torch.randn(*s, dtype=torch.bfloat16) * 0.4)(D, D)),
        }
    _A_in = _A_setup()

    def _B_setup():
        B, S, D = 1, 2048, 512
        return {
            "x": _w((lambda *s: torch.randn(*s, dtype=torch.bfloat16) * 0.2)(B, S, D)),
            "wqkv": _w((lambda *s: torch.randn(*s, dtype=torch.bfloat16) * 0.4)(D, 3 * D)),
            "wo": _w((lambda *s: torch.randn(*s, dtype=torch.bfloat16) * 0.4)(D, D)),
        }
    _B_in = _B_setup()

    return {
        "A_x": _A_in["x"],
        "A_wqkv": _A_in["wqkv"],
        "A_wo": _A_in["wo"],
        "B_x": _B_in["x"],
        "B_wqkv": _B_in["wqkv"],
        "B_wo": _B_in["wo"],
    }

def reference(A_x, A_wqkv, A_wo, B_x, B_wqkv, B_wo):
    def _A_ref(x, wqkv, wo):
        B, S, D = x.shape
        H = 32; Dh = D // H; W = 256
        qkv = (lambda x, *d: x.permute(*d))((x @ wqkv).reshape(B, S, 3, H, Dh), 2, 0, 3, 1, 4)
        q, k, v = qkv[0], qkv[1], qkv[2]
        scores = torch.einsum("bhqd,bhkd->bhqk", q, k) * (Dh ** -0.5)
        idx = torch.arange(S)
        mask = (idx[:, None] - idx[None, :] >= 0) & (idx[:, None] - idx[None, :] < W)
        scores = torch.where(mask[None, None], scores, -1e9)
        p = _softmax(scores, axis=-1)
        o = torch.einsum("bhqk,bhkd->bhqd", p, v)
        return (lambda x, *d: x.permute(*d))(o, 0, 2, 1, 3).reshape(B, S, D) @ wo

    def _B_ref(x, wqkv, wo):
        B, S, D = x.shape
        H = 32; Dh = D // H; W = 256
        qkv = (lambda x, *d: x.permute(*d))((x @ wqkv).reshape(B, S, 3, H, Dh), 2, 0, 3, 1, 4)
        q, k, v = qkv[0], qkv[1], qkv[2]
        scores = torch.einsum("bhqd,bhkd->bhqk", q, k) * (Dh ** -0.5)
        idx = torch.arange(S)
        mask = (idx[:, None] - idx[None, :] >= 0) & (idx[:, None] - idx[None, :] < W)
        scores = torch.where(mask[None, None], scores, -1e9)
        p = _softmax(scores, axis=-1)
        o = torch.einsum("bhqk,bhkd->bhqd", p, v)
        return (lambda x, *d: x.permute(*d))(o, 0, 2, 1, 3).reshape(B, S, D) @ wo

    a = _A_ref(A_x, A_wqkv, A_wo)
    b = _B_ref(B_x, B_wqkv, B_wo)
    return torch.concatenate([a, b], axis=-1)
```

```asm
; @launch grid=(256,1,1) block=(512,1,1) lds=163840
.amdgcn_target "amdgcn-amd-amdhsa--gfx950"
.text
.globl concat_heads__sliding_block__sliding_block__prompt_kernel
.p2align 8
.type concat_heads__sliding_block__sliding_block__prompt_kernel,@function
concat_heads__sliding_block__sliding_block__prompt_kernel:
    s_cmp_ge_u32 s2, 256
    s_cbranch_scc1 L_end
    s_load_dwordx8 s[32:39], s[0:1], 0
    s_load_dwordx8 s[40:47], s[0:1], 32
    s_load_dwordx2 s[48:49], s[0:1], 64
    v_lshrrev_b32 v1, 6, v0
    v_and_b32 v0, 63, v0
    s_and_b32 s54, s2, 7
    v_readfirstlane_b32 s3, v1
    s_lshr_b32 s55, s2, 3
    s_lshr_b32 s28, s54, 2
    s_and_b32 s54, s54, 3
    s_lshl_b32 s54, s54, 2
    s_lshr_b32 s29, s55, 3
    s_add_u32 s29, s29, s54
    s_and_b32 s30, s55, 7
    s_lshl_b32 s31, s28, 4
    s_add_u32 s31, s31, s29
    s_lshl_b32 s31, s31, 3
    s_add_u32 s31, s31, s30
    s_mov_b32 s6, 0x200000
    s_mov_b32 s7, 0x20000
    s_mov_b32 s10, 0x180000
    s_mov_b32 s11, 0x20000
    s_mov_b32 s14, 0x80000
    s_mov_b32 s15, 0x20000
    s_mov_b32 s18, 14680064
    s_mov_b32 s19, 0x20000
    s_mov_b32 s22, 0x400000
    s_mov_b32 s23, 0x20000
    s_mov_b32 s26, 256
    s_mov_b32 s27, 0x20000
    s_mov_b32 s60, 0xffff
    s_mov_b32 s61, 0xffff
    s_cmp_eq_u32 s28, 0
    s_waitcnt lgkmcnt(0)
    s_cselect_b32 s4, s32, s38
    s_cselect_b32 s5, s33, s39
    s_cselect_b32 s8, s34, s40
    s_cselect_b32 s9, s35, s41
    s_cselect_b32 s12, s36, s42
    s_cselect_b32 s13, s37, s43
    s_mov_b32 s20, s44
    s_mov_b32 s21, s45
    s_mov_b32 s24, s46
    s_mov_b32 s25, s47
    s_mov_b32 s16, s48
    s_mov_b32 s17, s49
    s_cmp_ge_u32 s3, 4
    s_cbranch_scc1 L_loader
    v_mov_b32 v12, 0
    v_lshlrev_b32 v13, 2, v0
    ds_write_b32 v13, v12 offset:4096
    s_waitcnt lgkmcnt(0)
    s_barrier
    s_cmp_lg_u32 s2, 0
    s_cbranch_scc1 L_noinit
    v_lshlrev_b32 v1, 4, v0
    v_mov_b32 v4, 0
    v_mov_b32 v5, 0
    v_mov_b32 v6, 0
    v_mov_b32 v7, 0
    s_lshl_b32 s54, s3, 13
    s_add_u32 s54, s54, 12582912
    s_add_u32 s55, s54, 8192
L_init:
    buffer_store_dwordx4 v[4:7], v1, s[16:19], s54 offen sc1
    s_add_u32 s54, s54, 1024
    s_cmp_lt_u32 s54, s55
    s_cbranch_scc1 L_init
L_noinit:
    v_and_b32 v7, 31, v0
    v_lshrrev_b32 v8, 5, v0
    v_lshrrev_b32 v9, 1, v7
    v_and_b32 v9, 7, v9
    v_xor_b32 v9, v9, v8
    v_lshlrev_b32 v9, 4, v9
    v_lshl_add_u32 v2, v7, 7, v9
    s_lshr_b32 s54, s3, 1
    s_lshl_b32 s54, s54, 13
    s_add_u32 s54, s54, 81920
    v_add_u32 v2, s54, v2
    v_xor_b32 v3, 32, v2
    v_xor_b32 v4, 64, v2
    v_xor_b32 v5, 96, v2
    v_bfe_u32 v9, v0, 2, 2
    v_lshl_add_u32 v9, v8, 3, v9
    v_lshlrev_b32 v6, 7, v9
    v_bfe_u32 v9, v0, 4, 1
    v_lshlrev_b32 v9, 1, v9
    v_bfe_u32 v10, v0, 1, 1
    v_or_b32 v9, v9, v10
    v_bfe_u32 v10, v0, 3, 1
    s_and_b32 s54, s3, 1
    v_xor_b32 v10, s54, v10
    v_lshl_or_b32 v9, v10, 2, v9
    v_lshl_add_u32 v6, v9, 4, v6
    v_and_b32 v9, 1, v0
    v_lshl_add_u32 v6, v9, 3, v6
    v_add_u32 v6, 81920, v6
    s_lshl_b32 s54, s3, 2
    v_mov_b32 v13, s54
    v_lshlrev_b32 v152, 4, v0
    v_bfe_u32 v10, v0, 4, 1
    v_and_b32 v11, 15, v0
    v_lshrrev_b32 v7, 5, v0
    v_lshl_or_b32 v11, v7, 4, v11
    v_lshlrev_b32 v11, 4, v11
    v_lshl_add_u32 v153, v10, 12, v11
    v_lshl_add_u32 v154, v10, 13, v11
    s_and_b32 s54, s3, 1
    s_lshr_b32 s55, s3, 1
    s_lshl_b32 s56, s54, 13
    s_lshl_b32 s66, s55, 11
    s_add_u32 s56, s56, s66
    s_add_u32 s56, s56, 70144
    v_add_u32 v155, s56, v152
    v_add_u32 v153, s56, v153
    s_lshl_b32 s39, s31, 15
    s_lshl_b32 s54, s54, 14
    s_add_u32 s39, s39, s54
    s_add_u32 s39, s39, s66
    s_add_u32 s40, s39, 8192
    s_add_u32 s41, s39, 4096
    v_mov_b32 v16, 0
    v_mov_b32 v17, 0
    v_mov_b32 v18, 0
    v_mov_b32 v19, 0
    v_mov_b32 v20, 0
    v_mov_b32 v21, 0
    v_mov_b32 v22, 0
    v_mov_b32 v23, 0
    v_mov_b32 v24, 0
    v_mov_b32 v25, 0
    v_mov_b32 v26, 0
    v_mov_b32 v27, 0
    v_mov_b32 v28, 0
    v_mov_b32 v29, 0
    v_mov_b32 v30, 0
    v_mov_b32 v31, 0
    v_mov_b32 v32, 0
    v_mov_b32 v33, 0
    v_mov_b32 v34, 0
    v_mov_b32 v35, 0
    v_mov_b32 v36, 0
    v_mov_b32 v37, 0
    v_mov_b32 v38, 0
    v_mov_b32 v39, 0
    v_mov_b32 v40, 0
    v_mov_b32 v41, 0
    v_mov_b32 v42, 0
    v_mov_b32 v43, 0
    v_mov_b32 v44, 0
    v_mov_b32 v45, 0
    v_mov_b32 v46, 0
    v_mov_b32 v47, 0
    v_mov_b32 v48, 0
    v_mov_b32 v49, 0
    v_mov_b32 v50, 0
    v_mov_b32 v51, 0
    v_mov_b32 v52, 0
    v_mov_b32 v53, 0
    v_mov_b32 v54, 0
    v_mov_b32 v55, 0
    v_mov_b32 v56, 0
    v_mov_b32 v57, 0
    v_mov_b32 v58, 0
    v_mov_b32 v59, 0
    v_mov_b32 v60, 0
    v_mov_b32 v61, 0
    v_mov_b32 v62, 0
    v_mov_b32 v63, 0
    v_mov_b32 v64, 0
    v_mov_b32 v65, 0
    v_mov_b32 v66, 0
    v_mov_b32 v67, 0
    v_mov_b32 v68, 0
    v_mov_b32 v69, 0
    v_mov_b32 v70, 0
    v_mov_b32 v71, 0
    v_mov_b32 v72, 0
    v_mov_b32 v73, 0
    v_mov_b32 v74, 0
    v_mov_b32 v75, 0
    v_mov_b32 v76, 0
    v_mov_b32 v77, 0
    v_mov_b32 v78, 0
    v_mov_b32 v79, 0
    v_mov_b32 v80, 0
    v_mov_b32 v81, 0
    v_mov_b32 v82, 0
    v_mov_b32 v83, 0
    v_mov_b32 v84, 0
    v_mov_b32 v85, 0
    v_mov_b32 v86, 0
    v_mov_b32 v87, 0
    v_mov_b32 v88, 0
    v_mov_b32 v89, 0
    v_mov_b32 v90, 0
    v_mov_b32 v91, 0
    v_mov_b32 v92, 0
    v_mov_b32 v93, 0
    v_mov_b32 v94, 0
    v_mov_b32 v95, 0
    v_mov_b32 v96, 0
    v_mov_b32 v97, 0
    v_mov_b32 v98, 0
    v_mov_b32 v99, 0
    v_mov_b32 v100, 0
    v_mov_b32 v101, 0
    v_mov_b32 v102, 0
    v_mov_b32 v103, 0
    v_mov_b32 v104, 0
    v_mov_b32 v105, 0
    v_mov_b32 v106, 0
    v_mov_b32 v107, 0
    v_mov_b32 v108, 0
    v_mov_b32 v109, 0
    v_mov_b32 v110, 0
    v_mov_b32 v111, 0
    v_mov_b32 v1, 0x3f803f80
    v_mov_b32 v168, v1
    v_mov_b32 v169, v1
    v_mov_b32 v170, v1
    v_mov_b32 v171, v1
    v_mov_b32 v172, v1
    v_mov_b32 v173, v1
    v_mov_b32 v174, v1
    v_mov_b32 v175, v1
    v_mov_b32 v176, v1
    v_mov_b32 v177, v1
    v_mov_b32 v178, v1
    v_mov_b32 v179, v1
    v_mov_b32 v180, v1
    v_mov_b32 v181, v1
    v_mov_b32 v182, v1
    v_mov_b32 v183, v1
    v_mov_b32 v184, v1
    v_mov_b32 v185, v1
    v_mov_b32 v186, v1
    v_mov_b32 v187, v1
    v_mov_b32 v188, v1
    v_mov_b32 v189, v1
    v_mov_b32 v190, v1
    v_mov_b32 v191, v1
    v_mov_b32 v192, v1
    v_mov_b32 v193, v1
    v_mov_b32 v194, v1
    v_mov_b32 v195, v1
    v_mov_b32 v196, v1
    v_mov_b32 v197, v1
    v_mov_b32 v198, v1
    v_mov_b32 v199, v1
    v_mov_b32 v200, v1
    v_mov_b32 v201, v1
    v_mov_b32 v202, v1
    v_mov_b32 v203, v1
    v_mov_b32 v204, v1
    v_mov_b32 v205, v1
    v_mov_b32 v206, v1
    v_mov_b32 v207, v1
    v_mov_b32 v208, v1
    v_mov_b32 v209, v1
    v_mov_b32 v210, v1
    v_mov_b32 v211, v1
    v_mov_b32 v212, v1
    v_mov_b32 v213, v1
    v_mov_b32 v214, v1
    v_mov_b32 v215, v1
    s_lshl_b32 s64, s31, 7
    s_add_u32 s64, s64, 12582912
    s_add_u32 s38, s64, 64
    s_mov_b32 s62, 1052289595
    s_mov_b32 s67, 729808896
    s_mov_b32 s68, 1400897536
    s_mov_b32 s53, 0
    s_mov_b32 s69, 1
L_c_spin0:
    ds_read_b128 v[8:11], v12 offset:4096
    s_waitcnt lgkmcnt(0)
    v_min3_u32 v8, v8, v9, v10
    v_min_u32 v8, v8, v11
    s_nop 0
    v_readfirstlane_b32 s55, v8
    s_nop 0
    s_cmp_lt_u32 s55, 1
    s_cbranch_scc1 L_c_spin0
    s_cmp_lg_u32 s2, 0
    s_cbranch_scc1 L_noann
    v_mov_b32 v14, 1
    s_mov_b64 exec, 1
    s_waitcnt vmcnt(0)
    buffer_store_dword v14, v13, s[24:27], 0 offen sc1
    s_mov_b64 exec, -1
L_noann:
    ds_read_b128 v[112:115], v2 offset:0
    ds_read_b64_tr_b16 v[120:121], v6 offset:16384
    ds_read_b64_tr_b16 v[122:123], v6 offset:16896
    ds_read_b128 v[116:119], v2 offset:4096
    ds_read_b64_tr_b16 v[124:125], v6 offset:24576
    ds_read_b64_tr_b16 v[126:127], v6 offset:25088
    ds_read_b64_tr_b16 v[128:129], v6 offset:32768
    ds_read_b64_tr_b16 v[130:131], v6 offset:33280
L_p1_loop:
    s_waitcnt lgkmcnt(5)
    v_mfma_f32_32x32x16_bf16 v[16:31], v[120:123], v[112:115], v[16:31]
    ds_read_b128 v[132:135], v3 offset:0
    ds_read_b64_tr_b16 v[140:141], v6 offset:18432
    s_waitcnt lgkmcnt(6)
    v_mfma_f32_32x32x16_bf16 v[32:47], v[120:123], v[116:119], v[32:47]
    ds_read_b64_tr_b16 v[142:143], v6 offset:18944
    ds_read_b128 v[136:139], v3 offset:4096
    s_waitcnt lgkmcnt(6)
    v_mfma_f32_32x32x16_bf16 v[48:63], v[124:127], v[112:115], v[48:63]
    ds_read_b64_tr_b16 v[144:145], v6 offset:26624
    ds_read_b64_tr_b16 v[146:147], v6 offset:27136
    v_mfma_f32_32x32x16_bf16 v[64:79], v[124:127], v[116:119], v[64:79]
    ds_read_b64_tr_b16 v[148:149], v6 offset:34816
    ds_read_b64_tr_b16 v[150:151], v6 offset:35328
    s_waitcnt lgkmcnt(8)
    v_mfma_f32_32x32x16_bf16 v[80:95], v[112:115], v[128:131], v[80:95]
    v_mfma_f32_32x32x16_bf16 v[96:111], v[116:119], v[128:131], v[96:111]
    s_waitcnt lgkmcnt(5)
    v_mfma_f32_32x32x16_bf16 v[16:31], v[140:143], v[132:135], v[16:31]
    ds_read_b128 v[112:115], v4 offset:0
    ds_read_b64_tr_b16 v[120:121], v6 offset:20480
    s_waitcnt lgkmcnt(6)
    v_mfma_f32_32x32x16_bf16 v[32:47], v[140:143], v[136:139], v[32:47]
    ds_read_b64_tr_b16 v[122:123], v6 offset:20992
    ds_read_b128 v[116:119], v4 offset:4096
    s_waitcnt lgkmcnt(6)
    v_mfma_f32_32x32x16_bf16 v[48:63], v[144:147], v[132:135], v[48:63]
    ds_read_b64_tr_b16 v[124:125], v6 offset:28672
    ds_read_b64_tr_b16 v[126:127], v6 offset:29184
    v_mfma_f32_32x32x16_bf16 v[64:79], v[144:147], v[136:139], v[64:79]
    ds_read_b64_tr_b16 v[128:129], v6 offset:36864
    ds_read_b64_tr_b16 v[130:131], v6 offset:37376
    s_waitcnt lgkmcnt(8)
    v_mfma_f32_32x32x16_bf16 v[80:95], v[132:135], v[148:151], v[80:95]
    v_mfma_f32_32x32x16_bf16 v[96:111], v[136:139], v[148:151], v[96:111]
    s_waitcnt lgkmcnt(5)
    v_mfma_f32_32x32x16_bf16 v[16:31], v[120:123], v[112:115], v[16:31]
    ds_read_b128 v[132:135], v5 offset:0
    ds_read_b64_tr_b16 v[140:141], v6 offset:22528
    s_waitcnt lgkmcnt(6)
    v_mfma_f32_32x32x16_bf16 v[32:47], v[120:123], v[116:119], v[32:47]
    ds_read_b64_tr_b16 v[142:143], v6 offset:23040
    ds_read_b128 v[136:139], v5 offset:4096
    s_waitcnt lgkmcnt(6)
    v_mfma_f32_32x32x16_bf16 v[48:63], v[124:127], v[112:115], v[48:63]
    ds_read_b64_tr_b16 v[144:145], v6 offset:30720
    ds_read_b64_tr_b16 v[146:147], v6 offset:31232
    v_mfma_f32_32x32x16_bf16 v[64:79], v[124:127], v[116:119], v[64:79]
    ds_read_b64_tr_b16 v[148:149], v6 offset:38912
    ds_read_b64_tr_b16 v[150:151], v6 offset:39424
    s_waitcnt lgkmcnt(8)
    v_mfma_f32_32x32x16_bf16 v[80:95], v[112:115], v[128:131], v[80:95]
    ds_read_b128 v[8:11], v12 offset:4096
    v_mfma_f32_32x32x16_bf16 v[96:111], v[116:119], v[128:131], v[96:111]
    s_waitcnt lgkmcnt(6)
    v_mfma_f32_32x32x16_bf16 v[16:31], v[140:143], v[132:135], v[16:31]
    s_add_u32 s53, s53, 1
    s_add_u32 s69, s69, 1
    s_mov_b32 s54, 40960
    s_cmp_eq_u32 s69, 3
    s_cselect_b32 s54, 4294885376, s54
    s_cselect_b32 s69, 0, s69
    v_mov_b32 v14, s53
    s_waitcnt lgkmcnt(5)
    v_mfma_f32_32x32x16_bf16 v[32:47], v[140:143], v[136:139], v[32:47]
    v_add_u32 v2, s54, v2
    v_add_u32 v3, s54, v3
    v_add_u32 v4, s54, v4
    v_add_u32 v5, s54, v5
    v_add_u32 v6, s54, v6
    s_waitcnt lgkmcnt(0)
    ds_write_b32 v13, v14 offset:4112
    v_min3_u32 v8, v8, v9, v10
    v_min_u32 v8, v8, v11
    s_nop 0
    v_readfirstlane_b32 s55, v8
    v_mfma_f32_32x32x16_bf16 v[48:63], v[144:147], v[132:135], v[48:63]
    s_min_u32 s66, s53, 7
    s_cmp_gt_u32 s55, s66
    s_cbranch_scc1 L_c_ok
L_c_spin:
    ds_read_b128 v[8:11], v12 offset:4096
    s_waitcnt lgkmcnt(0)
    v_min3_u32 v8, v8, v9, v10
    v_min_u32 v8, v8, v11
    s_nop 0
    v_readfirstlane_b32 s55, v8
    s_nop 0
    s_cmp_le_u32 s55, s66
    s_cbranch_scc1 L_c_spin
L_c_ok:
    ds_read_b128 v[112:115], v2 offset:0
    ds_read_b64_tr_b16 v[120:121], v6 offset:16384
    v_mfma_f32_32x32x16_bf16 v[64:79], v[144:147], v[136:139], v[64:79]
    ds_read_b64_tr_b16 v[122:123], v6 offset:16896
    ds_read_b128 v[116:119], v2 offset:4096
    ds_read_b64_tr_b16 v[124:125], v6 offset:24576
    v_mfma_f32_32x32x16_bf16 v[80:95], v[132:135], v[148:151], v[80:95]
    ds_read_b64_tr_b16 v[126:127], v6 offset:25088
    ds_read_b64_tr_b16 v[128:129], v6 offset:32768
    ds_read_b64_tr_b16 v[130:131], v6 offset:33280
    s_cmp_lt_u32 s53, 8
    v_mfma_f32_32x32x16_bf16 v[96:111], v[136:139], v[148:151], v[96:111]
    s_cbranch_scc1 L_p1_loop
L_c_spin2:
    ds_read_b128 v[8:11], v12 offset:4112
    s_waitcnt lgkmcnt(0)
    v_min3_u32 v8, v8, v9, v10
    v_min_u32 v8, v8, v11
    s_nop 0
    v_readfirstlane_b32 s55, v8
    s_nop 0
    s_cmp_lt_u32 s55, 7
    s_cbranch_scc1 L_c_spin2
    v_cvt_pk_bf16_f32 v112, v48, v49
    v_cvt_pk_bf16_f32 v113, v50, v51
    v_cvt_pk_bf16_f32 v114, v52, v53
    v_cvt_pk_bf16_f32 v115, v54, v55
    v_cvt_pk_bf16_f32 v116, v56, v57
    v_cvt_pk_bf16_f32 v117, v58, v59
    v_cvt_pk_bf16_f32 v118, v60, v61
    v_cvt_pk_bf16_f32 v119, v62, v63
    buffer_store_dwordx4 v[112:115], v152, s[16:19], s39 offen offset:0 sc1
    ds_write_b128 v155, v[112:115] offset:0
    buffer_store_dwordx4 v[116:119], v152, s[16:19], s40 offen offset:0 sc1
    ds_write_b128 v155, v[116:119] offset:4096
    v_cvt_pk_bf16_f32 v120, v64, v65
    v_cvt_pk_bf16_f32 v121, v66, v67
    v_cvt_pk_bf16_f32 v122, v68, v69
    v_cvt_pk_bf16_f32 v123, v70, v71
    v_cvt_pk_bf16_f32 v124, v72, v73
    v_cvt_pk_bf16_f32 v125, v74, v75
    v_cvt_pk_bf16_f32 v126, v76, v77
    v_cvt_pk_bf16_f32 v127, v78, v79
    buffer_store_dwordx4 v[120:123], v152, s[16:19], s39 offen offset:1024 sc1
    ds_write_b128 v155, v[120:123] offset:1024
    buffer_store_dwordx4 v[124:127], v152, s[16:19], s40 offen offset:1024 sc1
    ds_write_b128 v155, v[124:127] offset:5120
    v_cvt_pk_bf16_f32 v128, v80, v81
    v_cvt_pk_bf16_f32 v129, v82, v83
    v_cvt_pk_bf16_f32 v130, v84, v85
    v_cvt_pk_bf16_f32 v131, v86, v87
    v_cvt_pk_bf16_f32 v132, v88, v89
    v_cvt_pk_bf16_f32 v133, v90, v91
    v_cvt_pk_bf16_f32 v134, v92, v93
    v_cvt_pk_bf16_f32 v135, v94, v95
    buffer_store_dwordx4 v[128:131], v154, s[16:19], s41 offen offset:0 sc1
    ds_write_b128 v153, v[128:131] offset:16384
    buffer_store_dwordx4 v[132:135], v154, s[16:19], s41 offen offset:512 sc1
    ds_write_b128 v153, v[132:135] offset:16896
    v_cvt_pk_bf16_f32 v136, v96, v97
    v_cvt_pk_bf16_f32 v137, v98, v99
    v_cvt_pk_bf16_f32 v138, v100, v101
    v_cvt_pk_bf16_f32 v139, v102, v103
    v_cvt_pk_bf16_f32 v140, v104, v105
    v_cvt_pk_bf16_f32 v141, v106, v107
    v_cvt_pk_bf16_f32 v142, v108, v109
    v_cvt_pk_bf16_f32 v143, v110, v111
    buffer_store_dwordx4 v[136:139], v154, s[16:19], s41 offen offset:1024 sc1
    ds_write_b128 v153, v[136:139] offset:17408
    buffer_store_dwordx4 v[140:143], v154, s[16:19], s41 offen offset:1536 sc1
    ds_write_b128 v153, v[140:143] offset:17920
    v_pk_mul_f32 v[16:17], v[16:17], s[62:63] op_sel_hi:[1,0]
    v_pk_mul_f32 v[18:19], v[18:19], s[62:63] op_sel_hi:[1,0]
    v_pk_mul_f32 v[20:21], v[20:21], s[62:63] op_sel_hi:[1,0]
    v_pk_mul_f32 v[22:23], v[22:23], s[62:63] op_sel_hi:[1,0]
    v_pk_mul_f32 v[24:25], v[24:25], s[62:63] op_sel_hi:[1,0]
    v_pk_mul_f32 v[26:27], v[26:27], s[62:63] op_sel_hi:[1,0]
    v_pk_mul_f32 v[28:29], v[28:29], s[62:63] op_sel_hi:[1,0]
    v_pk_mul_f32 v[30:31], v[30:31], s[62:63] op_sel_hi:[1,0]
    v_cvt_pk_bf16_f32 v16, v16, v17
    v_cvt_pk_bf16_f32 v17, v18, v19
    v_cvt_pk_bf16_f32 v18, v20, v21
    v_cvt_pk_bf16_f32 v19, v22, v23
    v_cvt_pk_bf16_f32 v20, v24, v25
    v_cvt_pk_bf16_f32 v21, v26, v27
    v_cvt_pk_bf16_f32 v22, v28, v29
    v_cvt_pk_bf16_f32 v23, v30, v31
    ds_write_b128 v155, v[16:19] offset:32768
    ds_write_b128 v155, v[20:23] offset:36864
    v_pk_mul_f32 v[32:33], v[32:33], s[62:63] op_sel_hi:[1,0]
    v_pk_mul_f32 v[34:35], v[34:35], s[62:63] op_sel_hi:[1,0]
    v_pk_mul_f32 v[36:37], v[36:37], s[62:63] op_sel_hi:[1,0]
    v_pk_mul_f32 v[38:39], v[38:39], s[62:63] op_sel_hi:[1,0]
    v_pk_mul_f32 v[40:41], v[40:41], s[62:63] op_sel_hi:[1,0]
    v_pk_mul_f32 v[42:43], v[42:43], s[62:63] op_sel_hi:[1,0]
    v_pk_mul_f32 v[44:45], v[44:45], s[62:63] op_sel_hi:[1,0]
    v_pk_mul_f32 v[46:47], v[46:47], s[62:63] op_sel_hi:[1,0]
    v_cvt_pk_bf16_f32 v32, v32, v33
    v_cvt_pk_bf16_f32 v33, v34, v35
    v_cvt_pk_bf16_f32 v34, v36, v37
    v_cvt_pk_bf16_f32 v35, v38, v39
    v_cvt_pk_bf16_f32 v36, v40, v41
    v_cvt_pk_bf16_f32 v37, v42, v43
    v_cvt_pk_bf16_f32 v38, v44, v45
    v_cvt_pk_bf16_f32 v39, v46, v47
    ds_write_b128 v155, v[32:35] offset:33792
    ds_write_b128 v155, v[36:39] offset:37888
    s_and_b32 s54, s3, 3
    s_lshl_b32 s55, s54, 12
    s_add_u32 s55, s55, 70144
    v_lshlrev_b32 v2, 4, v0
    v_add_u32 v7, s55, v2
    v_and_b32 v11, 15, v0
    v_lshrrev_b32 v12, 5, v0
    v_lshl_or_b32 v11, v12, 4, v11
    v_lshlrev_b32 v3, 4, v11
    v_add_u32 v8, s55, v3
    v_add_u32 v3, 4096, v3
    s_lshl_b32 s33, s31, 2
    s_add_u32 s33, s33, s54
    s_lshl_b32 s33, s33, 13
    s_sub_u32 s34, s33, 524288
    s_sub_u32 s33, s33, 262144
    s_lshl_b32 s65, s31, 14
    s_lshl_b32 s55, s54, 10
    s_add_u32 s65, s65, s55
    s_add_u32 s65, s65, 8388608
    s_and_b32 s54, s3, 1
    s_lshl_b32 s55, s54, 10
    s_sub_u32 s55, s64, s55
    s_sub_u32 s55, s55, 1024
    v_mov_b32 v4, s55
    s_min_u32 s55, s29, 2
    s_lshr_b32 s51, s3, 1
    s_and_b32 s51, s51, 2
    s_xor_b32 s51, s51, s3
    s_and_b32 s51, s51, 3
    s_cmp_lt_u32 s51, s55
    s_cselect_b32 s50, 1, 0
    s_lshl_b32 s50, s50, s54
    s_mov_b32 s51, 1
    v_lshrrev_b32 v1, 3, v0
    v_and_b32 v5, 7, v0
    v_bfe_u32 v6, v0, 4, 1
    v_lshlrev_b32 v6, 2, v6
    v_xor_b32 v5, v5, v6
    v_lshlrev_b32 v5, 4, v5
    v_lshl_add_u32 v1, v1, 10, v5
    s_and_b32 s54, s3, 7
    s_lshl_b32 s48, s54, 13
    s_add_u32 s48, s48, 4608
    s_lshl_b32 s49, s54, 16
    s_lshl_b32 s54, s30, 7
    s_add_u32 s49, s49, s54
    s_cmp_eq_u32 s29, 0
    s_cselect_b32 s32, 1, 0
    s_mov_b32 s37, 0
    s_mul_i32 s54, s3, 4608
    s_add_u32 s54, s54, 122880
    v_add_u32 v5, s54, v2
    v_lshl_add_u32 v10, v0, 2, s54
    s_xor_b32 s54, s3, 4
    s_mul_i32 s54, s54, 4608
    s_add_u32 s54, s54, 122880
    v_add_u32 v6, s54, v2
    v_lshl_add_u32 v11, v0, 2, s54
    s_andn2_b32 s56, s31, 7
    s_add_u32 s56, s56, s3
    s_lshl_b32 s56, s56, 7
    s_add_u32 s56, s56, 12582976
    v_mov_b32 v9, s56
    v_mov_b32 v12, 0
    s_waitcnt lgkmcnt(0)
    s_barrier
    v_mov_b32 v14, 1
    s_mov_b64 exec, 1
    s_waitcnt vmcnt(0)
    ds_add_rtn_u32 v13, v12, v14 offset:4128
    s_waitcnt lgkmcnt(0)
    v_readfirstlane_b32 s54, v13
    s_nop 0
    s_cmp_lg_u32 s54, 3
    s_cbranch_scc1 L_pubk
    buffer_store_dword v14, v12, s[16:19], s64 offen sc1
L_pubk:
    s_mov_b64 exec, -1
    s_cmp_eq_u32 s50, 0
    s_cbranch_scc1 L_pix0
    s_mov_b64 exec, 1
    buffer_load_dword v15, v4, s[16:19], 0 offen sc1
    s_mov_b64 exec, -1
L_pix0:
    ds_read_b128 v[16:19], v7 offset:32768
    ds_read_b128 v[20:23], v7 offset:33792
    ds_read_b128 v[24:27], v7 offset:34816
    ds_read_b128 v[28:31], v7 offset:35840
    ds_read_b128 v[144:147], v7 offset:0
    ds_read_b128 v[148:151], v7 offset:3072
    ds_read_b128 v[128:131], v2 offset:0
    ds_read_b128 v[132:135], v2 offset:1024
    ds_read_b128 v[136:139], v2 offset:2048
    ds_read_b128 v[140:143], v2 offset:3072
    s_mov_b64 exec, s[60:61]
    ds_read_b128 v[168:171], v8 offset:16384
    ds_read_b128 v[172:175], v8 offset:16896
    ds_read_b128 v[176:179], v8 offset:19456
    ds_read_b128 v[180:183], v8 offset:19968
    s_mov_b64 exec, -1
    s_waitcnt lgkmcnt(4)
    v_mfma_f32_32x32x16_bf16 v[96:111], v[144:147], v[16:19], v[128:143]
    v_mfma_f32_32x32x16_bf16 v[112:127], v[144:147], v[20:23], 0
    s_nop 10
    v_exp_f32 v96, v96
    v_exp_f32 v97, v97
    v_exp_f32 v98, v98
    v_cvt_pk_bf16_f32 v96, v96, v97
    v_exp_f32 v99, v99
    v_exp_f32 v100, v100
    v_cvt_pk_bf16_f32 v97, v98, v99
    v_exp_f32 v101, v101
    v_exp_f32 v102, v102
    v_cvt_pk_bf16_f32 v98, v100, v101
    v_exp_f32 v103, v103
    v_exp_f32 v104, v104
    v_cvt_pk_bf16_f32 v99, v102, v103
    v_exp_f32 v105, v105
    v_exp_f32 v106, v106
    v_cvt_pk_bf16_f32 v104, v104, v105
    v_exp_f32 v107, v107
    s_waitcnt lgkmcnt(0)
    v_mfma_f32_32x32x16_bf16 v[32:47], v[168:171], v[96:99], 0
    v_exp_f32 v108, v108
    v_cvt_pk_bf16_f32 v105, v106, v107
    v_exp_f32 v109, v109
    v_exp_f32 v110, v110
    v_cvt_pk_bf16_f32 v106, v108, v109
    v_exp_f32 v111, v111
    s_nop 0
    v_cvt_pk_bf16_f32 v107, v110, v111
    v_exp_f32 v112, v112
    v_exp_f32 v113, v113
    v_mfma_f32_32x32x16_bf16 v[32:47], v[172:175], v[104:107], v[32:47]
    v_mfma_f32_32x32x16_bf16 v[96:111], v[144:147], v[24:27], 0
    v_exp_f32 v114, v114
    v_cvt_pk_bf16_f32 v112, v112, v113
    v_exp_f32 v115, v115
    v_exp_f32 v116, v116
    v_cvt_pk_bf16_f32 v113, v114, v115
    v_exp_f32 v117, v117
    v_exp_f32 v118, v118
    v_cvt_pk_bf16_f32 v114, v116, v117
    v_exp_f32 v119, v119
    v_exp_f32 v120, v120
    v_cvt_pk_bf16_f32 v115, v118, v119
    v_exp_f32 v121, v121
    v_exp_f32 v122, v122
    v_cvt_pk_bf16_f32 v120, v120, v121
    v_exp_f32 v123, v123
    v_mfma_f32_32x32x16_bf16 v[48:63], v[168:171], v[112:115], 0
    v_exp_f32 v124, v124
    v_cvt_pk_bf16_f32 v121, v122, v123
    v_exp_f32 v125, v125
    v_exp_f32 v126, v126
    v_cvt_pk_bf16_f32 v122, v124, v125
    v_exp_f32 v127, v127
    s_nop 0
    v_cvt_pk_bf16_f32 v123, v126, v127
    s_cmp_lg_u32 s32, 0
    s_cbranch_scc1 L_tl0m3
    s_cmp_eq_u32 s50, 0
    s_cbranch_scc1 L_pck0m3
    s_waitcnt vmcnt(0)
    v_readfirstlane_b32 s54, v15
    v_mov_b32 v14, s50
    s_cmp_lg_u32 s54, 1
    s_cbranch_scc1 L_pck0m3
    s_mov_b64 exec, 1
    ds_or_b32 v12, v14 offset:4144
    s_mov_b64 exec, -1
    s_mov_b32 s50, 0
L_pck0m3:
    ds_read_b32 v14, v12 offset:4144
    s_waitcnt lgkmcnt(0)
    v_readfirstlane_b32 s54, v14
    s_nop 0
    s_andn2_b32 s50, s50, s54
    s_cmp_eq_u32 s50, 0
    s_cbranch_scc1 L_pik0m3
    s_mov_b64 exec, 1
    buffer_load_dword v15, v4, s[16:19], 0 offen sc1
    s_mov_b64 exec, -1
L_pik0m3:
    s_and_b32 s54, s54, s51
    s_cmp_lg_u32 s54, s51
    s_cbranch_scc1 L_tl0m3
    buffer_load_dwordx4 v[152:155], v2, s[16:19], s33 offen offset:3072 sc1
    s_mov_b64 exec, s[60:61]
    buffer_load_dwordx4 v[184:187], v3, s[16:19], s33 offen offset:3072 sc1
    buffer_load_dwordx4 v[188:191], v3, s[16:19], s33 offen offset:3584 sc1
    s_mov_b64 exec, -1
    buffer_load_dwordx4 v[156:159], v2, s[16:19], s33 offen offset:2048 sc1
    s_mov_b64 exec, s[60:61]
    buffer_load_dwordx4 v[192:195], v3, s[16:19], s33 offen offset:2048 sc1
    buffer_load_dwordx4 v[196:199], v3, s[16:19], s33 offen offset:2560 sc1
    s_mov_b64 exec, -1
    s_mov_b32 s32, 1
    s_andn2_b32 s50, s50, s51
L_tl0m3:
    v_exp_f32 v96, v96
    v_exp_f32 v97, v97
    v_mfma_f32_32x32x16_bf16 v[48:63], v[172:175], v[120:123], v[48:63]
    v_mfma_f32_32x32x16_bf16 v[112:127], v[144:147], v[28:31], 0
    v_exp_f32 v98, v98
    v_cvt_pk_bf16_f32 v96, v96, v97
    v_exp_f32 v99, v99
    v_exp_f32 v100, v100
    v_cvt_pk_bf16_f32 v97, v98, v99
    v_exp_f32 v101, v101
    v_exp_f32 v102, v102
    v_cvt_pk_bf16_f32 v98, v100, v101
    v_exp_f32 v103, v103
    v_exp_f32 v104, v104
    v_cvt_pk_bf16_f32 v99, v102, v103
    v_exp_f32 v105, v105
    v_exp_f32 v106, v106
    v_cvt_pk_bf16_f32 v104, v104, v105
    v_exp_f32 v107, v107
    v_mfma_f32_32x32x16_bf16 v[64:79], v[168:171], v[96:99], 0
    v_exp_f32 v108, v108
    v_cvt_pk_bf16_f32 v105, v106, v107
    v_exp_f32 v109, v109
    v_exp_f32 v110, v110
    v_cvt_pk_bf16_f32 v106, v108, v109
    v_exp_f32 v111, v111
    s_nop 0
    v_cvt_pk_bf16_f32 v107, v110, v111
    v_exp_f32 v112, v112
    v_exp_f32 v113, v113
    v_mfma_f32_32x32x16_bf16 v[64:79], v[172:175], v[104:107], v[64:79]
    v_mfma_f32_32x32x16_bf16 v[96:111], v[148:151], v[28:31], v[128:143]
    v_exp_f32 v114, v114
    v_cvt_pk_bf16_f32 v112, v112, v113
    v_exp_f32 v115, v115
    v_exp_f32 v116, v116
    v_cvt_pk_bf16_f32 v113, v114, v115
    v_exp_f32 v117, v117
    v_exp_f32 v118, v118
    v_cvt_pk_bf16_f32 v114, v116, v117
    v_exp_f32 v119, v119
    v_exp_f32 v120, v120
    v_cvt_pk_bf16_f32 v115, v118, v119
    v_exp_f32 v121, v121
    v_exp_f32 v122, v122
    v_cvt_pk_bf16_f32 v120, v120, v121
    v_exp_f32 v123, v123
    v_mfma_f32_32x32x16_bf16 v[80:95], v[168:171], v[112:115], 0
    v_exp_f32 v124, v124
    v_cvt_pk_bf16_f32 v121, v122, v123
    v_exp_f32 v125, v125
    v_exp_f32 v126, v126
    v_cvt_pk_bf16_f32 v122, v124, v125
    v_exp_f32 v127, v127
    s_nop 0
    v_cvt_pk_bf16_f32 v123, v126, v127
    s_cmp_lg_u32 s32, 0
    s_cbranch_scc1 L_tl0m4
    s_cmp_eq_u32 s50, 0
    s_cbranch_scc1 L_pck0m4
    s_waitcnt vmcnt(0)
    v_readfirstlane_b32 s54, v15
    v_mov_b32 v14, s50
    s_cmp_lg_u32 s54, 1
    s_cbranch_scc1 L_pck0m4
    s_mov_b64 exec, 1
    ds_or_b32 v12, v14 offset:4144
    s_mov_b64 exec, -1
    s_mov_b32 s50, 0
L_pck0m4:
    ds_read_b32 v14, v12 offset:4144
    s_waitcnt lgkmcnt(0)
    v_readfirstlane_b32 s54, v14
    s_nop 0
    s_andn2_b32 s50, s50, s54
    s_cmp_eq_u32 s50, 0
    s_cbranch_scc1 L_pik0m4
    s_mov_b64 exec, 1
    buffer_load_dword v15, v4, s[16:19], 0 offen sc1
    s_mov_b64 exec, -1
L_pik0m4:
    s_and_b32 s54, s54, s51
    s_cmp_lg_u32 s54, s51
    s_cbranch_scc1 L_tl0m4
    buffer_load_dwordx4 v[152:155], v2, s[16:19], s33 offen offset:3072 sc1
    s_mov_b64 exec, s[60:61]
    buffer_load_dwordx4 v[184:187], v3, s[16:19], s33 offen offset:3072 sc1
    buffer_load_dwordx4 v[188:191], v3, s[16:19], s33 offen offset:3584 sc1
    s_mov_b64 exec, -1
    buffer_load_dwordx4 v[156:159], v2, s[16:19], s33 offen offset:2048 sc1
    s_mov_b64 exec, s[60:61]
    buffer_load_dwordx4 v[192:195], v3, s[16:19], s33 offen offset:2048 sc1
    buffer_load_dwordx4 v[196:199], v3, s[16:19], s33 offen offset:2560 sc1
    s_mov_b64 exec, -1
    s_mov_b32 s32, 1
    s_andn2_b32 s50, s50, s51
L_tl0m4:
    v_exp_f32 v96, v96
    v_exp_f32 v97, v97
    v_mfma_f32_32x32x16_bf16 v[80:95], v[172:175], v[120:123], v[80:95]
    v_exp_f32 v98, v98
    v_cvt_pk_bf16_f32 v96, v96, v97
    v_exp_f32 v99, v99
    v_exp_f32 v100, v100
    v_cvt_pk_bf16_f32 v97, v98, v99
    v_exp_f32 v101, v101
    v_exp_f32 v102, v102
    v_cvt_pk_bf16_f32 v98, v100, v101
    v_exp_f32 v103, v103
    v_exp_f32 v104, v104
    v_cvt_pk_bf16_f32 v99, v102, v103
    v_exp_f32 v105, v105
    v_exp_f32 v106, v106
    v_cvt_pk_bf16_f32 v104, v104, v105
    v_exp_f32 v107, v107
    v_mfma_f32_32x32x16_bf16 v[80:95], v[176:179], v[96:99], v[80:95]
    v_exp_f32 v108, v108
    v_cvt_pk_bf16_f32 v105, v106, v107
    v_exp_f32 v109, v109
    v_exp_f32 v110, v110
    v_cvt_pk_bf16_f32 v106, v108, v109
    v_exp_f32 v111, v111
    s_nop 0
    v_cvt_pk_bf16_f32 v107, v110, v111
    s_nop 1
    v_mfma_f32_32x32x16_bf16 v[80:95], v[180:183], v[104:107], v[80:95]
    s_cmp_lg_u32 s32, 0
    s_cbranch_scc1 L_have0
    s_mov_b32 s63, 0
L_pkv0n:
    s_cmp_eq_u32 s50, 0
    s_cbranch_scc1 L_pck0bn
    s_waitcnt vmcnt(0)
    v_readfirstlane_b32 s54, v15
    v_mov_b32 v14, s50
    s_cmp_lg_u32 s54, 1
    s_cbranch_scc1 L_pck0bn
    s_mov_b64 exec, 1
    ds_or_b32 v12, v14 offset:4144
    s_mov_b64 exec, -1
    s_mov_b32 s50, 0
L_pck0bn:
    ds_read_b32 v14, v12 offset:4144
    s_waitcnt lgkmcnt(0)
    v_readfirstlane_b32 s54, v14
    s_nop 0
    s_andn2_b32 s50, s50, s54
    s_cmp_eq_u32 s50, 0
    s_cbranch_scc1 L_pik0bn
    s_mov_b64 exec, 1
    buffer_load_dword v15, v4, s[16:19], 0 offen sc1
    s_mov_b64 exec, -1
L_pik0bn:
    s_and_b32 s54, s54, s51
    s_cmp_eq_u32 s54, s51
    s_cbranch_scc1 L_pkv0n_ok
    s_add_u32 s63, s63, 1
    s_sleep 2
    s_cmp_lt_u32 s63, 0x40000
    s_cbranch_scc1 L_pkv0n
L_pkv0n_ok:
    buffer_load_dwordx4 v[152:155], v2, s[16:19], s33 offen offset:3072 sc1
    s_mov_b64 exec, s[60:61]
    buffer_load_dwordx4 v[184:187], v3, s[16:19], s33 offen offset:3072 sc1
    buffer_load_dwordx4 v[188:191], v3, s[16:19], s33 offen offset:3584 sc1
    s_mov_b64 exec, -1
    buffer_load_dwordx4 v[156:159], v2, s[16:19], s33 offen offset:2048 sc1
    s_mov_b64 exec, s[60:61]
    buffer_load_dwordx4 v[192:195], v3, s[16:19], s33 offen offset:2048 sc1
    buffer_load_dwordx4 v[196:199], v3, s[16:19], s33 offen offset:2560 sc1
    s_mov_b64 exec, -1
    s_mov_b32 s32, 1
    s_andn2_b32 s50, s50, s51
L_have0:
    s_cmp_eq_u32 s29, 0
    s_cbranch_scc1 L_z0
    s_cmp_eq_u32 s29, 1
    s_cbranch_scc1 L_B0_only
    v_sub_f32 v128, 4048155338, v128
    v_sub_f32 v129, 4048155338, v129
    v_sub_f32 v130, 4048155338, v130
    v_sub_f32 v131, 4048155338, v131
    v_sub_f32 v132, 4048155338, v132
    v_sub_f32 v133, 4048155338, v133
    v_sub_f32 v134, 4048155338, v134
    v_sub_f32 v135, 4048155338, v135
    v_sub_f32 v136, 4048155338, v136
    v_sub_f32 v137, 4048155338, v137
    v_sub_f32 v138, 4048155338, v138
    v_sub_f32 v139, 4048155338, v139
    v_sub_f32 v140, 4048155338, v140
    v_sub_f32 v141, 4048155338, v141
    v_sub_f32 v142, 4048155338, v142
    v_sub_f32 v143, 4048155338, v143
    s_waitcnt vmcnt(3)
    v_mfma_f32_32x32x16_bf16 v[96:111], v[152:155], v[16:19], 0
    v_mfma_f32_32x32x16_bf16 v[112:127], v[152:155], v[20:23], 0
    s_nop 10
    v_exp_f32 v96, v96
    v_exp_f32 v97, v97
    v_exp_f32 v98, v98
    v_cvt_pk_bf16_f32 v96, v96, v97
    v_exp_f32 v99, v99
    v_exp_f32 v100, v100
    v_cvt_pk_bf16_f32 v97, v98, v99
    v_exp_f32 v101, v101
    v_exp_f32 v102, v102
    v_cvt_pk_bf16_f32 v98, v100, v101
    v_exp_f32 v103, v103
    v_exp_f32 v104, v104
    v_cvt_pk_bf16_f32 v99, v102, v103
    v_exp_f32 v105, v105
    v_exp_f32 v106, v106
    v_cvt_pk_bf16_f32 v104, v104, v105
    v_exp_f32 v107, v107
    v_mfma_f32_32x32x16_bf16 v[32:47], v[184:187], v[96:99], v[32:47]
    v_exp_f32 v108, v108
    v_cvt_pk_bf16_f32 v105, v106, v107
    v_exp_f32 v109, v109
    v_exp_f32 v110, v110
    v_cvt_pk_bf16_f32 v106, v108, v109
    v_exp_f32 v111, v111
    s_nop 0
    v_cvt_pk_bf16_f32 v107, v110, v111
    v_exp_f32 v112, v112
    v_exp_f32 v113, v113
    v_mfma_f32_32x32x16_bf16 v[32:47], v[188:191], v[104:107], v[32:47]
    v_mfma_f32_32x32x16_bf16 v[96:111], v[152:155], v[24:27], 0
    v_exp_f32 v114, v114
    v_cvt_pk_bf16_f32 v112, v112, v113
    v_exp_f32 v115, v115
    v_exp_f32 v116, v116
    v_cvt_pk_bf16_f32 v113, v114, v115
    v_exp_f32 v117, v117
    v_exp_f32 v118, v118
    v_cvt_pk_bf16_f32 v114, v116, v117
    v_exp_f32 v119, v119
    v_exp_f32 v120, v120
    v_cvt_pk_bf16_f32 v115, v118, v119
    v_exp_f32 v121, v121
    v_exp_f32 v122, v122
    v_cvt_pk_bf16_f32 v120, v120, v121
    v_exp_f32 v123, v123
    v_mfma_f32_32x32x16_bf16 v[48:63], v[184:187], v[112:115], v[48:63]
    v_exp_f32 v124, v124
    v_cvt_pk_bf16_f32 v121, v122, v123
    v_exp_f32 v125, v125
    v_exp_f32 v126, v126
    v_cvt_pk_bf16_f32 v122, v124, v125
    v_exp_f32 v127, v127
    s_nop 0
    v_cvt_pk_bf16_f32 v123, v126, v127
    s_mov_b32 s51, 2
    s_mov_b32 s63, 0
L_pkv0f:
    s_cmp_eq_u32 s50, 0
    s_cbranch_scc1 L_pck0bf
    s_waitcnt vmcnt(0)
    v_readfirstlane_b32 s54, v15
    v_mov_b32 v14, s50
    s_cmp_lg_u32 s54, 1
    s_cbranch_scc1 L_pck0bf
    s_mov_b64 exec, 1
    ds_or_b32 v12, v14 offset:4144
    s_mov_b64 exec, -1
    s_mov_b32 s50, 0
L_pck0bf:
    ds_read_b32 v14, v12 offset:4144
    s_waitcnt lgkmcnt(0)
    v_readfirstlane_b32 s54, v14
    s_nop 0
    s_andn2_b32 s50, s50, s54
    s_cmp_eq_u32 s50, 0
    s_cbranch_scc1 L_pik0bf
    s_mov_b64 exec, 1
    buffer_load_dword v15, v4, s[16:19], 0 offen sc1
    s_mov_b64 exec, -1
L_pik0bf:
    s_and_b32 s54, s54, s51
    s_cmp_eq_u32 s54, s51
    s_cbranch_scc1 L_pkv0f_ok
    s_add_u32 s63, s63, 1
    s_sleep 2
    s_cmp_lt_u32 s63, 0x40000
    s_cbranch_scc1 L_pkv0f
L_pkv0f_ok:
    buffer_load_dwordx4 v[160:163], v2, s[16:19], s34 offen offset:3072 sc1
    s_mov_b64 exec, s[60:61]
    buffer_load_dwordx4 v[200:203], v3, s[16:19], s34 offen offset:3072 sc1
    buffer_load_dwordx4 v[204:207], v3, s[16:19], s34 offen offset:3584 sc1
    s_mov_b64 exec, -1
    buffer_load_dwordx4 v[164:167], v2, s[16:19], s34 offen offset:0 sc1
    s_mov_b64 exec, s[60:61]
    buffer_load_dwordx4 v[208:211], v3, s[16:19], s34 offen offset:0 sc1
    buffer_load_dwordx4 v[212:215], v3, s[16:19], s34 offen offset:512 sc1
    s_mov_b64 exec, -1
    s_mov_b32 s32, 1
    s_andn2_b32 s50, s50, s51
    v_exp_f32 v96, v96
    v_exp_f32 v97, v97
    v_mfma_f32_32x32x16_bf16 v[48:63], v[188:191], v[120:123], v[48:63]
    v_mfma_f32_32x32x16_bf16 v[112:127], v[152:155], v[28:31], 0
    v_exp_f32 v98, v98
    v_cvt_pk_bf16_f32 v96, v96, v97
    v_exp_f32 v99, v99
    v_exp_f32 v100, v100
    v_cvt_pk_bf16_f32 v97, v98, v99
    v_exp_f32 v101, v101
    v_exp_f32 v102, v102
    v_cvt_pk_bf16_f32 v98, v100, v101
    v_exp_f32 v103, v103
    v_exp_f32 v104, v104
    v_cvt_pk_bf16_f32 v99, v102, v103
    v_exp_f32 v105, v105
    v_exp_f32 v106, v106
    v_cvt_pk_bf16_f32 v104, v104, v105
    v_exp_f32 v107, v107
    v_mfma_f32_32x32x16_bf16 v[64:79], v[184:187], v[96:99], v[64:79]
    v_exp_f32 v108, v108
    v_cvt_pk_bf16_f32 v105, v106, v107
    v_exp_f32 v109, v109
    v_exp_f32 v110, v110
    v_cvt_pk_bf16_f32 v106, v108, v109
    v_exp_f32 v111, v111
    s_nop 0
    v_cvt_pk_bf16_f32 v107, v110, v111
    v_exp_f32 v112, v112
    v_exp_f32 v113, v113
    v_mfma_f32_32x32x16_bf16 v[64:79], v[188:191], v[104:107], v[64:79]
    s_waitcnt vmcnt(6)
    v_mfma_f32_32x32x16_bf16 v[96:111], v[156:159], v[16:19], 0
    v_exp_f32 v114, v114
    v_cvt_pk_bf16_f32 v112, v112, v113
    v_exp_f32 v115, v115
    v_exp_f32 v116, v116
    v_cvt_pk_bf16_f32 v113, v114, v115
    v_exp_f32 v117, v117
    v_exp_f32 v118, v118
    v_cvt_pk_bf16_f32 v114, v116, v117
    v_exp_f32 v119, v119
    v_exp_f32 v120, v120
    v_cvt_pk_bf16_f32 v115, v118, v119
    v_exp_f32 v121, v121
    v_exp_f32 v122, v122
    v_cvt_pk_bf16_f32 v120, v120, v121
    v_exp_f32 v123, v123
    v_mfma_f32_32x32x16_bf16 v[80:95], v[184:187], v[112:115], v[80:95]
    v_exp_f32 v124, v124
    v_cvt_pk_bf16_f32 v121, v122, v123
    v_exp_f32 v125, v125
    v_exp_f32 v126, v126
    v_cvt_pk_bf16_f32 v122, v124, v125
    v_exp_f32 v127, v127
    s_nop 0
    v_cvt_pk_bf16_f32 v123, v126, v127
    s_add_u32 m0, s48, 0
    s_add_u32 s54, s49, 0
    buffer_load_dwordx4 v1, s[12:15], s54 offen lds
    v_exp_f32 v96, v96
    v_exp_f32 v97, v97
    v_mfma_f32_32x32x16_bf16 v[80:95], v[188:191], v[120:123], v[80:95]
    v_mfma_f32_32x32x16_bf16 v[112:127], v[156:159], v[20:23], 0
    v_exp_f32 v98, v98
    v_cvt_pk_bf16_f32 v96, v96, v97
    v_exp_f32 v99, v99
    v_exp_f32 v100, v100
    v_cvt_pk_bf16_f32 v97, v98, v99
    v_exp_f32 v101, v101
    v_exp_f32 v102, v102
    v_cvt_pk_bf16_f32 v98, v100, v101
    v_exp_f32 v103, v103
    v_exp_f32 v104, v104
    v_cvt_pk_bf16_f32 v99, v102, v103
    v_exp_f32 v105, v105
    v_exp_f32 v106, v106
    v_cvt_pk_bf16_f32 v104, v104, v105
    v_exp_f32 v107, v107
    v_mfma_f32_32x32x16_bf16 v[32:47], v[192:195], v[96:99], v[32:47]
    v_exp_f32 v108, v108
    v_cvt_pk_bf16_f32 v105, v106, v107
    v_exp_f32 v109, v109
    v_exp_f32 v110, v110
    v_cvt_pk_bf16_f32 v106, v108, v109
    v_exp_f32 v111, v111
    s_nop 0
    v_cvt_pk_bf16_f32 v107, v110, v111
    s_add_u32 m0, s48, 1024
    s_add_u32 s54, s49, 8192
    buffer_load_dwordx4 v1, s[12:15], s54 offen lds
    v_exp_f32 v112, v112
    v_exp_f32 v113, v113
    v_mfma_f32_32x32x16_bf16 v[32:47], v[196:199], v[104:107], v[32:47]
    v_mfma_f32_32x32x16_bf16 v[96:111], v[156:159], v[24:27], 0
    v_exp_f32 v114, v114
    v_cvt_pk_bf16_f32 v112, v112, v113
    v_exp_f32 v115, v115
    v_exp_f32 v116, v116
    v_cvt_pk_bf16_f32 v113, v114, v115
    v_exp_f32 v117, v117
    v_exp_f32 v118, v118
    v_cvt_pk_bf16_f32 v114, v116, v117
    v_exp_f32 v119, v119
    v_exp_f32 v120, v120
    v_cvt_pk_bf16_f32 v115, v118, v119
    v_exp_f32 v121, v121
    v_exp_f32 v122, v122
    v_cvt_pk_bf16_f32 v120, v120, v121
    v_exp_f32 v123, v123
    v_mfma_f32_32x32x16_bf16 v[48:63], v[192:195], v[112:115], v[48:63]
    v_exp_f32 v124, v124
    v_cvt_pk_bf16_f32 v121, v122, v123
    v_exp_f32 v125, v125
    v_exp_f32 v126, v126
    v_cvt_pk_bf16_f32 v122, v124, v125
    v_exp_f32 v127, v127
    s_nop 0
    v_cvt_pk_bf16_f32 v123, v126, v127
    s_add_u32 m0, s48, 2048
    s_add_u32 s54, s49, 16384
    buffer_load_dwordx4 v1, s[12:15], s54 offen lds
    v_exp_f32 v96, v96
    v_exp_f32 v97, v97
    v_mfma_f32_32x32x16_bf16 v[48:63], v[196:199], v[120:123], v[48:63]
    v_mfma_f32_32x32x16_bf16 v[112:127], v[156:159], v[28:31], 0
    v_exp_f32 v98, v98
    v_cvt_pk_bf16_f32 v96, v96, v97
    v_exp_f32 v99, v99
    v_exp_f32 v100, v100
    v_cvt_pk_bf16_f32 v97, v98, v99
    v_exp_f32 v101, v101
    v_exp_f32 v102, v102
    v_cvt_pk_bf16_f32 v98, v100, v101
    v_exp_f32 v103, v103
    v_exp_f32 v104, v104
    v_cvt_pk_bf16_f32 v99, v102, v103
    v_exp_f32 v105, v105
    v_exp_f32 v106, v106
    v_cvt_pk_bf16_f32 v104, v104, v105
    v_exp_f32 v107, v107
    v_mfma_f32_32x32x16_bf16 v[64:79], v[192:195], v[96:99], v[64:79]
    v_exp_f32 v108, v108
    v_cvt_pk_bf16_f32 v105, v106, v107
    v_exp_f32 v109, v109
    v_exp_f32 v110, v110
    v_cvt_pk_bf16_f32 v106, v108, v109
    v_exp_f32 v111, v111
    s_nop 0
    v_cvt_pk_bf16_f32 v107, v110, v111
    s_add_u32 m0, s48, 3072
    s_add_u32 s54, s49, 24576
    buffer_load_dwordx4 v1, s[12:15], s54 offen lds
    v_exp_f32 v112, v112
    v_exp_f32 v113, v113
    v_mfma_f32_32x32x16_bf16 v[64:79], v[196:199], v[104:107], v[64:79]
    s_waitcnt vmcnt(7)
    v_mfma_f32_32x32x16_bf16 v[96:111], v[160:163], v[16:19], 0
    v_exp_f32 v114, v114
    v_cvt_pk_bf16_f32 v112, v112, v113
    v_exp_f32 v115, v115
    v_exp_f32 v116, v116
    v_cvt_pk_bf16_f32 v113, v114, v115
    v_exp_f32 v117, v117
    v_exp_f32 v118, v118
    v_cvt_pk_bf16_f32 v114, v116, v117
    v_exp_f32 v119, v119
    v_exp_f32 v120, v120
    v_cvt_pk_bf16_f32 v115, v118, v119
    v_exp_f32 v121, v121
    v_exp_f32 v122, v122
    v_cvt_pk_bf16_f32 v120, v120, v121
    v_exp_f32 v123, v123
    v_mfma_f32_32x32x16_bf16 v[80:95], v[192:195], v[112:115], v[80:95]
    v_exp_f32 v124, v124
    v_cvt_pk_bf16_f32 v121, v122, v123
    v_exp_f32 v125, v125
    v_exp_f32 v126, v126
    v_cvt_pk_bf16_f32 v122, v124, v125
    v_exp_f32 v127, v127
    s_nop 0
    v_cvt_pk_bf16_f32 v123, v126, v127
    s_add_u32 m0, s48, 4096
    s_add_u32 s54, s49, 32768
    buffer_load_dwordx4 v1, s[12:15], s54 offen lds
    v_exp_f32 v96, v96
    v_exp_f32 v97, v97
    v_mfma_f32_32x32x16_bf16 v[80:95], v[196:199], v[120:123], v[80:95]
    v_mfma_f32_32x32x16_bf16 v[112:127], v[160:163], v[20:23], 0
    v_exp_f32 v98, v98
    v_cvt_pk_bf16_f32 v96, v96, v97
    v_exp_f32 v99, v99
    v_exp_f32 v100, v100
    v_cvt_pk_bf16_f32 v97, v98, v99
    v_exp_f32 v101, v101
    v_exp_f32 v102, v102
    v_cvt_pk_bf16_f32 v98, v100, v101
    v_exp_f32 v103, v103
    v_exp_f32 v104, v104
    v_cvt_pk_bf16_f32 v99, v102, v103
    v_exp_f32 v105, v105
    v_exp_f32 v106, v106
    v_cvt_pk_bf16_f32 v104, v104, v105
    v_exp_f32 v107, v107
    v_mfma_f32_32x32x16_bf16 v[32:47], v[200:203], v[96:99], v[32:47]
    v_exp_f32 v108, v108
    v_cvt_pk_bf16_f32 v105, v106, v107
    v_exp_f32 v109, v109
    v_exp_f32 v110, v110
    v_cvt_pk_bf16_f32 v106, v108, v109
    v_exp_f32 v111, v111
    s_nop 0
    v_cvt_pk_bf16_f32 v107, v110, v111
    s_add_u32 m0, s48, 5120
    s_add_u32 s54, s49, 40960
    buffer_load_dwordx4 v1, s[12:15], s54 offen lds
    v_exp_f32 v112, v112
    v_exp_f32 v113, v113
    v_mfma_f32_32x32x16_bf16 v[32:47], v[204:207], v[104:107], v[32:47]
    v_mfma_f32_32x32x16_bf16 v[96:111], v[160:163], v[24:27], 0
    v_exp_f32 v114, v114
    v_cvt_pk_bf16_f32 v112, v112, v113
    v_exp_f32 v115, v115
    v_exp_f32 v116, v116
    v_cvt_pk_bf16_f32 v113, v114, v115
    v_exp_f32 v117, v117
    v_exp_f32 v118, v118
    v_cvt_pk_bf16_f32 v114, v116, v117
    v_exp_f32 v119, v119
    v_exp_f32 v120, v120
    v_cvt_pk_bf16_f32 v115, v118, v119
    v_exp_f32 v121, v121
    v_exp_f32 v122, v122
    v_cvt_pk_bf16_f32 v120, v120, v121
    v_exp_f32 v123, v123
    v_mfma_f32_32x32x16_bf16 v[48:63], v[200:203], v[112:115], v[48:63]
    v_exp_f32 v124, v124
    v_cvt_pk_bf16_f32 v121, v122, v123
    v_exp_f32 v125, v125
    v_exp_f32 v126, v126
    v_cvt_pk_bf16_f32 v122, v124, v125
    v_exp_f32 v127, v127
    s_nop 0
    v_cvt_pk_bf16_f32 v123, v126, v127
    s_add_u32 m0, s48, 6144
    s_add_u32 s54, s49, 49152
    buffer_load_dwordx4 v1, s[12:15], s54 offen lds
    v_exp_f32 v96, v96
    v_exp_f32 v97, v97
    v_mfma_f32_32x32x16_bf16 v[48:63], v[204:207], v[120:123], v[48:63]
    v_mfma_f32_32x32x16_bf16 v[112:127], v[160:163], v[28:31], v[128:143]
    v_exp_f32 v98, v98
    v_cvt_pk_bf16_f32 v96, v96, v97
    v_exp_f32 v99, v99
    v_exp_f32 v100, v100
    v_cvt_pk_bf16_f32 v97, v98, v99
    v_exp_f32 v101, v101
    v_exp_f32 v102, v102
    v_cvt_pk_bf16_f32 v98, v100, v101
    v_exp_f32 v103, v103
    v_exp_f32 v104, v104
    v_cvt_pk_bf16_f32 v99, v102, v103
    v_exp_f32 v105, v105
    v_exp_f32 v106, v106
    v_cvt_pk_bf16_f32 v104, v104, v105
    v_exp_f32 v107, v107
    v_mfma_f32_32x32x16_bf16 v[64:79], v[200:203], v[96:99], v[64:79]
    v_exp_f32 v108, v108
    v_cvt_pk_bf16_f32 v105, v106, v107
    v_exp_f32 v109, v109
    v_exp_f32 v110, v110
    v_cvt_pk_bf16_f32 v106, v108, v109
    v_exp_f32 v111, v111
    s_nop 0
    v_cvt_pk_bf16_f32 v107, v110, v111
    s_add_u32 m0, s48, 7168
    s_add_u32 s54, s49, 57344
    buffer_load_dwordx4 v1, s[12:15], s54 offen lds
    v_exp_f32 v112, v112
    v_exp_f32 v113, v113
    v_mfma_f32_32x32x16_bf16 v[64:79], v[204:207], v[104:107], v[64:79]
    s_waitcnt vmcnt(8)
    v_mfma_f32_32x32x16_bf16 v[96:111], v[164:167], v[16:19], v[128:143]
    v_exp_f32 v114, v114
    v_cvt_pk_bf16_f32 v112, v112, v113
    v_exp_f32 v115, v115
    v_exp_f32 v116, v116
    v_cvt_pk_bf16_f32 v113, v114, v115
    v_exp_f32 v117, v117
    v_exp_f32 v118, v118
    v_cvt_pk_bf16_f32 v114, v116, v117
    v_exp_f32 v119, v119
    v_exp_f32 v120, v120
    v_cvt_pk_bf16_f32 v115, v118, v119
    v_exp_f32 v121, v121
    v_exp_f32 v122, v122
    v_cvt_pk_bf16_f32 v120, v120, v121
    v_exp_f32 v123, v123
    v_mfma_f32_32x32x16_bf16 v[80:95], v[200:203], v[112:115], v[80:95]
    v_exp_f32 v124, v124
    v_cvt_pk_bf16_f32 v121, v122, v123
    v_exp_f32 v125, v125
    v_exp_f32 v126, v126
    v_cvt_pk_bf16_f32 v122, v124, v125
    v_exp_f32 v127, v127
    s_nop 0
    v_cvt_pk_bf16_f32 v123, v126, v127
    v_exp_f32 v96, v96
    v_exp_f32 v97, v97
    v_mfma_f32_32x32x16_bf16 v[80:95], v[204:207], v[120:123], v[80:95]
    v_exp_f32 v98, v98
    v_cvt_pk_bf16_f32 v96, v96, v97
    v_exp_f32 v99, v99
    v_exp_f32 v100, v100
    v_cvt_pk_bf16_f32 v97, v98, v99
    v_exp_f32 v101, v101
    v_exp_f32 v102, v102
    v_cvt_pk_bf16_f32 v98, v100, v101
    v_exp_f32 v103, v103
    v_exp_f32 v104, v104
    v_cvt_pk_bf16_f32 v99, v102, v103
    v_exp_f32 v105, v105
    v_exp_f32 v106, v106
    v_cvt_pk_bf16_f32 v104, v104, v105
    v_exp_f32 v107, v107
    v_mfma_f32_32x32x16_bf16 v[32:47], v[208:211], v[96:99], v[32:47]
    v_exp_f32 v108, v108
    v_cvt_pk_bf16_f32 v105, v106, v107
    v_exp_f32 v109, v109
    v_exp_f32 v110, v110
    v_cvt_pk_bf16_f32 v106, v108, v109
    v_exp_f32 v111, v111
    s_nop 0
    v_cvt_pk_bf16_f32 v107, v110, v111
    s_nop 1
    v_mfma_f32_32x32x16_bf16 v[32:47], v[212:215], v[104:107], v[32:47]
    s_branch L_fin0
L_z0:
    s_add_u32 m0, s48, 0
    s_add_u32 s54, s49, 0
    buffer_load_dwordx4 v1, s[12:15], s54 offen lds
    s_add_u32 m0, s48, 1024
    s_add_u32 s54, s49, 8192
    buffer_load_dwordx4 v1, s[12:15], s54 offen lds
    s_add_u32 m0, s48, 2048
    s_add_u32 s54, s49, 16384
    buffer_load_dwordx4 v1, s[12:15], s54 offen lds
    s_add_u32 m0, s48, 3072
    s_add_u32 s54, s49, 24576
    buffer_load_dwordx4 v1, s[12:15], s54 offen lds
    s_add_u32 m0, s48, 4096
    s_add_u32 s54, s49, 32768
    buffer_load_dwordx4 v1, s[12:15], s54 offen lds
    s_add_u32 m0, s48, 5120
    s_add_u32 s54, s49, 40960
    buffer_load_dwordx4 v1, s[12:15], s54 offen lds
    s_add_u32 m0, s48, 6144
    s_add_u32 s54, s49, 49152
    buffer_load_dwordx4 v1, s[12:15], s54 offen lds
    s_add_u32 m0, s48, 7168
    s_add_u32 s54, s49, 57344
    buffer_load_dwordx4 v1, s[12:15], s54 offen lds
    s_branch L_fin0
L_B0_only:
    s_waitcnt vmcnt(3)
    v_mfma_f32_32x32x16_bf16 v[96:111], v[152:155], v[16:19], 0
    v_mfma_f32_32x32x16_bf16 v[112:127], v[152:155], v[20:23], 0
    s_add_u32 m0, s48, 0
    s_add_u32 s54, s49, 0
    buffer_load_dwordx4 v1, s[12:15], s54 offen lds
    s_nop 7
    v_exp_f32 v96, v96
    v_exp_f32 v97, v97
    v_exp_f32 v98, v98
    v_cvt_pk_bf16_f32 v96, v96, v97
    v_exp_f32 v99, v99
    v_exp_f32 v100, v100
    v_cvt_pk_bf16_f32 v97, v98, v99
    v_exp_f32 v101, v101
    v_exp_f32 v102, v102
    v_cvt_pk_bf16_f32 v98, v100, v101
    v_exp_f32 v103, v103
    v_exp_f32 v104, v104
    v_cvt_pk_bf16_f32 v99, v102, v103
    v_exp_f32 v105, v105
    v_exp_f32 v106, v106
    v_cvt_pk_bf16_f32 v104, v104, v105
    v_exp_f32 v107, v107
    v_mfma_f32_32x32x16_bf16 v[32:47], v[184:187], v[96:99], v[32:47]
    v_exp_f32 v108, v108
    v_cvt_pk_bf16_f32 v105, v106, v107
    v_exp_f32 v109, v109
    v_exp_f32 v110, v110
    v_cvt_pk_bf16_f32 v106, v108, v109
    v_exp_f32 v111, v111
    s_nop 0
    v_cvt_pk_bf16_f32 v107, v110, v111
    s_add_u32 m0, s48, 1024
    s_add_u32 s54, s49, 8192
    buffer_load_dwordx4 v1, s[12:15], s54 offen lds
    v_exp_f32 v112, v112
    v_exp_f32 v113, v113
    v_mfma_f32_32x32x16_bf16 v[32:47], v[188:191], v[104:107], v[32:47]
    v_mfma_f32_32x32x16_bf16 v[96:111], v[152:155], v[24:27], 0
    v_exp_f32 v114, v114
    v_cvt_pk_bf16_f32 v112, v112, v113
    v_exp_f32 v115, v115
    v_exp_f32 v116, v116
    v_cvt_pk_bf16_f32 v113, v114, v115
    v_exp_f32 v117, v117
    v_exp_f32 v118, v118
    v_cvt_pk_bf16_f32 v114, v116, v117
    v_exp_f32 v119, v119
    v_exp_f32 v120, v120
    v_cvt_pk_bf16_f32 v115, v118, v119
    v_exp_f32 v121, v121
    v_exp_f32 v122, v122
    v_cvt_pk_bf16_f32 v120, v120, v121
    v_exp_f32 v123, v123
    v_mfma_f32_32x32x16_bf16 v[48:63], v[184:187], v[112:115], v[48:63]
    v_exp_f32 v124, v124
    v_cvt_pk_bf16_f32 v121, v122, v123
    v_exp_f32 v125, v125
    v_exp_f32 v126, v126
    v_cvt_pk_bf16_f32 v122, v124, v125
    v_exp_f32 v127, v127
    s_nop 0
    v_cvt_pk_bf16_f32 v123, v126, v127
    s_add_u32 m0, s48, 2048
    s_add_u32 s54, s49, 16384
    buffer_load_dwordx4 v1, s[12:15], s54 offen lds
    v_exp_f32 v96, v96
    v_exp_f32 v97, v97
    v_mfma_f32_32x32x16_bf16 v[48:63], v[188:191], v[120:123], v[48:63]
    v_mfma_f32_32x32x16_bf16 v[112:127], v[152:155], v[28:31], 0
    v_exp_f32 v98, v98
    v_cvt_pk_bf16_f32 v96, v96, v97
    v_exp_f32 v99, v99
    v_exp_f32 v100, v100
    v_cvt_pk_bf16_f32 v97, v98, v99
    v_exp_f32 v101, v101
    v_exp_f32 v102, v102
    v_cvt_pk_bf16_f32 v98, v100, v101
    v_exp_f32 v103, v103
    v_exp_f32 v104, v104
    v_cvt_pk_bf16_f32 v99, v102, v103
    v_exp_f32 v105, v105
    v_exp_f32 v106, v106
    v_cvt_pk_bf16_f32 v104, v104, v105
    v_exp_f32 v107, v107
    v_mfma_f32_32x32x16_bf16 v[64:79], v[184:187], v[96:99], v[64:79]
    v_exp_f32 v108, v108
    v_cvt_pk_bf16_f32 v105, v106, v107
    v_exp_f32 v109, v109
    v_exp_f32 v110, v110
    v_cvt_pk_bf16_f32 v106, v108, v109
    v_exp_f32 v111, v111
    s_nop 0
    v_cvt_pk_bf16_f32 v107, v110, v111
    s_add_u32 m0, s48, 3072
    s_add_u32 s54, s49, 24576
    buffer_load_dwordx4 v1, s[12:15], s54 offen lds
    v_exp_f32 v112, v112
    v_exp_f32 v113, v113
    v_mfma_f32_32x32x16_bf16 v[64:79], v[188:191], v[104:107], v[64:79]
    s_waitcnt vmcnt(4)
    v_mfma_f32_32x32x16_bf16 v[96:111], v[156:159], v[16:19], 0
    v_exp_f32 v114, v114
    v_cvt_pk_bf16_f32 v112, v112, v113
    v_exp_f32 v115, v115
    v_exp_f32 v116, v116
    v_cvt_pk_bf16_f32 v113, v114, v115
    v_exp_f32 v117, v117
    v_exp_f32 v118, v118
    v_cvt_pk_bf16_f32 v114, v116, v117
    v_exp_f32 v119, v119
    v_exp_f32 v120, v120
    v_cvt_pk_bf16_f32 v115, v118, v119
    v_exp_f32 v121, v121
    v_exp_f32 v122, v122
    v_cvt_pk_bf16_f32 v120, v120, v121
    v_exp_f32 v123, v123
    v_mfma_f32_32x32x16_bf16 v[80:95], v[184:187], v[112:115], v[80:95]
    v_exp_f32 v124, v124
    v_cvt_pk_bf16_f32 v121, v122, v123
    v_exp_f32 v125, v125
    v_exp_f32 v126, v126
    v_cvt_pk_bf16_f32 v122, v124, v125
    v_exp_f32 v127, v127
    s_nop 0
    v_cvt_pk_bf16_f32 v123, v126, v127
    s_add_u32 m0, s48, 4096
    s_add_u32 s54, s49, 32768
    buffer_load_dwordx4 v1, s[12:15], s54 offen lds
    v_exp_f32 v96, v96
    v_exp_f32 v97, v97
    v_mfma_f32_32x32x16_bf16 v[80:95], v[188:191], v[120:123], v[80:95]
    v_mfma_f32_32x32x16_bf16 v[112:127], v[156:159], v[20:23], 0
    v_exp_f32 v98, v98
    v_cvt_pk_bf16_f32 v96, v96, v97
    v_exp_f32 v99, v99
    v_exp_f32 v100, v100
    v_cvt_pk_bf16_f32 v97, v98, v99
    v_exp_f32 v101, v101
    v_exp_f32 v102, v102
    v_cvt_pk_bf16_f32 v98, v100, v101
    v_exp_f32 v103, v103
    v_exp_f32 v104, v104
    v_cvt_pk_bf16_f32 v99, v102, v103
    v_exp_f32 v105, v105
    v_exp_f32 v106, v106
    v_cvt_pk_bf16_f32 v104, v104, v105
    v_exp_f32 v107, v107
    v_mfma_f32_32x32x16_bf16 v[32:47], v[192:195], v[96:99], v[32:47]
    v_exp_f32 v108, v108
    v_cvt_pk_bf16_f32 v105, v106, v107
    v_exp_f32 v109, v109
    v_exp_f32 v110, v110
    v_cvt_pk_bf16_f32 v106, v108, v109
    v_exp_f32 v111, v111
    s_nop 0
    v_cvt_pk_bf16_f32 v107, v110, v111
    s_add_u32 m0, s48, 5120
    s_add_u32 s54, s49, 40960
    buffer_load_dwordx4 v1, s[12:15], s54 offen lds
    v_exp_f32 v112, v112
    v_exp_f32 v113, v113
    v_mfma_f32_32x32x16_bf16 v[32:47], v[196:199], v[104:107], v[32:47]
    v_mfma_f32_32x32x16_bf16 v[96:111], v[156:159], v[24:27], 0
    v_exp_f32 v114, v114
    v_cvt_pk_bf16_f32 v112, v112, v113
    v_exp_f32 v115, v115
    v_exp_f32 v116, v116
    v_cvt_pk_bf16_f32 v113, v114, v115
    v_exp_f32 v117, v117
    v_exp_f32 v118, v118
    v_cvt_pk_bf16_f32 v114, v116, v117
    v_exp_f32 v119, v119
    v_exp_f32 v120, v120
    v_cvt_pk_bf16_f32 v115, v118, v119
    v_exp_f32 v121, v121
    v_exp_f32 v122, v122
    v_cvt_pk_bf16_f32 v120, v120, v121
    v_exp_f32 v123, v123
    v_mfma_f32_32x32x16_bf16 v[48:63], v[192:195], v[112:115], v[48:63]
    v_exp_f32 v124, v124
    v_cvt_pk_bf16_f32 v121, v122, v123
    v_exp_f32 v125, v125
    v_exp_f32 v126, v126
    v_cvt_pk_bf16_f32 v122, v124, v125
    v_exp_f32 v127, v127
    s_nop 0
    v_cvt_pk_bf16_f32 v123, v126, v127
    s_add_u32 m0, s48, 6144
    s_add_u32 s54, s49, 49152
    buffer_load_dwordx4 v1, s[12:15], s54 offen lds
    v_exp_f32 v96, v96
    v_exp_f32 v97, v97
    v_mfma_f32_32x32x16_bf16 v[48:63], v[196:199], v[120:123], v[48:63]
    v_mfma_f32_32x32x16_bf16 v[112:127], v[156:159], v[28:31], 0
    v_exp_f32 v98, v98
    v_cvt_pk_bf16_f32 v96, v96, v97
    v_exp_f32 v99, v99
    v_exp_f32 v100, v100
    v_cvt_pk_bf16_f32 v97, v98, v99
    v_exp_f32 v101, v101
    v_exp_f32 v102, v102
    v_cvt_pk_bf16_f32 v98, v100, v101
    v_exp_f32 v103, v103
    v_exp_f32 v104, v104
    v_cvt_pk_bf16_f32 v99, v102, v103
    v_exp_f32 v105, v105
    v_exp_f32 v106, v106
    v_cvt_pk_bf16_f32 v104, v104, v105
    v_exp_f32 v107, v107
    v_mfma_f32_32x32x16_bf16 v[64:79], v[192:195], v[96:99], v[64:79]
    v_exp_f32 v108, v108
    v_cvt_pk_bf16_f32 v105, v106, v107
    v_exp_f32 v109, v109
    v_exp_f32 v110, v110
    v_cvt_pk_bf16_f32 v106, v108, v109
    v_exp_f32 v111, v111
    s_nop 0
    v_cvt_pk_bf16_f32 v107, v110, v111
    s_add_u32 m0, s48, 7168
    s_add_u32 s54, s49, 57344
    buffer_load_dwordx4 v1, s[12:15], s54 offen lds
    v_exp_f32 v112, v112
    v_exp_f32 v113, v113
    v_mfma_f32_32x32x16_bf16 v[64:79], v[196:199], v[104:107], v[64:79]
    v_exp_f32 v114, v114
    v_cvt_pk_bf16_f32 v112, v112, v113
    v_exp_f32 v115, v115
    v_exp_f32 v116, v116
    v_cvt_pk_bf16_f32 v113, v114, v115
    v_exp_f32 v117, v117
    v_exp_f32 v118, v118
    v_cvt_pk_bf16_f32 v114, v116, v117
    v_exp_f32 v119, v119
    v_exp_f32 v120, v120
    v_cvt_pk_bf16_f32 v115, v118, v119
    v_exp_f32 v121, v121
    v_exp_f32 v122, v122
    v_cvt_pk_bf16_f32 v120, v120, v121
    v_exp_f32 v123, v123
    v_mfma_f32_32x32x16_bf16 v[80:95], v[192:195], v[112:115], v[80:95]
    v_exp_f32 v124, v124
    v_cvt_pk_bf16_f32 v121, v122, v123
    v_exp_f32 v125, v125
    v_exp_f32 v126, v126
    v_cvt_pk_bf16_f32 v122, v124, v125
    v_exp_f32 v127, v127
    s_nop 0
    v_cvt_pk_bf16_f32 v123, v126, v127
    s_nop 1
    v_mfma_f32_32x32x16_bf16 v[80:95], v[196:199], v[120:123], v[80:95]
L_fin0:
    s_setprio 0
    s_nop 10
    ds_write_b128 v5, v[64:67] offset:0
    ds_write_b128 v5, v[68:71] offset:1024
    ds_write_b32 v10, v72 offset:4096
    ds_write_b128 v5, v[80:83] offset:2048
    ds_write_b128 v5, v[84:87] offset:3072
    ds_write_b32 v10, v88 offset:4352
    s_waitcnt vmcnt(0) lgkmcnt(0)
    s_barrier
    s_lshl_b32 s54, s3, 2
    s_lshl_b32 s50, 1, s54
    s_cmp_eq_u32 s3, s30
    s_cselect_b32 s50, 0, s50
    s_cmp_eq_u32 s50, 0
    s_cbranch_scc1 L_pio0
    s_mov_b64 exec, 1
    buffer_load_dword v15, v9, s[16:19], 0 offen sc1
    s_mov_b64 exec, -1
L_pio0:
    ds_read_b32 v112, v11 offset:4096
    ds_read_b128 v[96:99], v6 offset:0
    ds_read_b128 v[100:103], v6 offset:1024
    ds_read_b32 v113, v11 offset:4352
    ds_read_b128 v[104:107], v6 offset:2048
    ds_read_b128 v[108:111], v6 offset:3072
    s_waitcnt lgkmcnt(3)
    v_add_f32 v112, v112, v40
    v_add_f32 v96, v96, v32
    v_add_f32 v97, v97, v33
    v_add_f32 v98, v98, v34
    v_add_f32 v99, v99, v35
    v_add_f32 v100, v100, v36
    v_add_f32 v101, v101, v37
    v_add_f32 v102, v102, v38
    v_add_f32 v103, v103, v39
    s_waitcnt lgkmcnt(0)
    v_add_f32 v113, v113, v56
    v_add_f32 v104, v104, v48
    v_add_f32 v105, v105, v49
    v_add_f32 v106, v106, v50
    v_add_f32 v107, v107, v51
    v_add_f32 v108, v108, v52
    v_add_f32 v109, v109, v53
    v_add_f32 v110, v110, v54
    v_add_f32 v111, v111, v55
    s_branch L_final
L_loader:
    v_lshrrev_b32 v6, 3, v0
    v_and_b32 v7, 7, v0
    v_lshrrev_b32 v8, 4, v0
    v_xor_b32 v9, v7, v8
    v_lshlrev_b32 v9, 4, v9
    v_lshl_add_u32 v2, v6, 10, v9
    v_xor_b32 v3, 64, v2
    v_and_b32 v8, 1, v8
    v_lshlrev_b32 v8, 2, v8
    v_xor_b32 v9, v7, v8
    v_lshlrev_b32 v9, 4, v9
    v_mul_u32_u24 v4, 3072, v6
    v_add_u32 v4, v4, v9
    v_lshl_add_u32 v5, v6, 10, v9
    s_sub_u32 s54, s3, 4
    s_lshl_b32 s50, s29, 17
    s_lshl_b32 s55, s54, 15
    s_add_u32 s50, s50, s55
    s_mul_i32 s51, s54, 49152
    s_lshl_b32 s55, s30, 7
    s_add_u32 s51, s51, s55
    s_lshl_b32 s56, s54, 12
    s_add_u32 s56, s56, 81920
    s_lshl_b32 s57, s54, 11
    s_add_u32 s57, s57, 98304
    s_lshl_b32 s54, s54, 2
    v_mov_b32 v10, 0
    v_mov_b32 v11, s54
    s_mov_b32 s53, 0
    s_mov_b32 s69, 1
L_ld_loop:
    s_add_u32 m0, s56, 0
    s_add_u32 s54, s50, 0
    buffer_load_dwordx4 v2, s[4:7], s54 offen lds
    s_add_u32 m0, s56, 1024
    s_add_u32 s54, s50, 8192
    buffer_load_dwordx4 v3, s[4:7], s54 offen lds
    s_add_u32 m0, s56, 2048
    s_add_u32 s54, s50, 16384
    buffer_load_dwordx4 v2, s[4:7], s54 offen lds
    s_add_u32 m0, s56, 3072
    s_add_u32 s54, s50, 24576
    buffer_load_dwordx4 v3, s[4:7], s54 offen lds
    s_add_u32 m0, s57, 0
    s_add_u32 s54, s51, 0
    buffer_load_dwordx4 v4, s[8:11], s54 offen lds
    s_add_u32 m0, s57, 1024
    s_add_u32 s54, s51, 24576
    buffer_load_dwordx4 v4, s[8:11], s54 offen lds
    s_add_u32 m0, s57, 8192
    s_add_u32 s54, s51, 1024
    buffer_load_dwordx4 v4, s[8:11], s54 offen lds
    s_add_u32 m0, s57, 9216
    s_add_u32 s54, s51, 25600
    buffer_load_dwordx4 v4, s[8:11], s54 offen lds
    s_add_u32 m0, s57, 16384
    s_add_u32 s54, s51, 2048
    buffer_load_dwordx4 v4, s[8:11], s54 offen lds
    s_add_u32 m0, s57, 17408
    s_add_u32 s54, s51, 26624
    buffer_load_dwordx4 v4, s[8:11], s54 offen lds
    s_add_u32 s50, s50, 128
    s_add_u32 s51, s51, 196608
    s_add_u32 s69, s69, 1
    s_mov_b32 s54, 40960
    s_cmp_eq_u32 s69, 3
    s_cselect_b32 s54, 4294885376, s54
    s_cselect_b32 s69, 0, s69
    s_add_u32 s56, s56, s54
    s_add_u32 s57, s57, s54
    s_cmp_lg_u32 s53, 0
    s_cbranch_scc1 L_ld_sig
    s_barrier
    s_mov_b32 s53, 1
    s_branch L_ld_loop
L_ld_sig:
    v_mov_b32 v12, s53
    s_add_u32 s53, s53, 1
    s_waitcnt vmcnt(10)
    ds_write_b32 v11, v12 offset:4096
    s_cmp_lt_u32 s53, 3
    s_cbranch_scc1 L_ld_loop
    s_cmp_eq_u32 s53, 8
    s_cbranch_scc1 L_ld_done
    s_sub_u32 s66, s53, 2
    ds_read_b128 v[16:19], v10 offset:4112
    s_waitcnt lgkmcnt(0)
    v_min3_u32 v16, v16, v17, v18
    v_min_u32 v16, v16, v19
    s_nop 0
    v_readfirstlane_b32 s55, v16
    s_nop 0
    s_cmp_ge_u32 s55, s66
    s_cbranch_scc1 L_ld_loop
    v_mov_b32 v12, s53
    s_waitcnt vmcnt(0)
    ds_write_b32 v11, v12 offset:4096
L_ld_spin:
    ds_read_b128 v[16:19], v10 offset:4112
    s_waitcnt lgkmcnt(0)
    v_min3_u32 v16, v16, v17, v18
    v_min_u32 v16, v16, v19
    s_nop 0
    v_readfirstlane_b32 s55, v16
    s_nop 0
    s_cmp_ge_u32 s55, s66
    s_cbranch_scc1 L_ld_loop
    s_branch L_ld_spin
L_ld_done:
    v_and_b32 v13, 3, v0
    v_lshlrev_b32 v13, 2, v13
    buffer_load_dword v7, v13, s[24:27], 0 offen sc1
    v_mov_b32 v12, 8
    s_waitcnt vmcnt(1)
    ds_write_b32 v11, v12 offset:4096
    v_and_b32 v6, 31, v0
    v_lshrrev_b32 v9, 5, v0
    v_lshlrev_b32 v9, 2, v9
    v_sub_u32 v6, v6, v9
    v_cvt_f32_i32 v6, v6
    s_mov_b32 s54, 4048155338
    v_lshlrev_b32 v8, 4, v0
    v_sub_f32 v128, 0, v6
    v_med3_f32 v128, v128, 0, 1.0
    v_mul_f32 v128, s54, v128
    v_sub_f32 v129, 1065353216, v6
    v_med3_f32 v129, v129, 0, 1.0
    v_mul_f32 v129, s54, v129
    v_sub_f32 v130, 1073741824, v6
    v_med3_f32 v130, v130, 0, 1.0
    v_mul_f32 v130, s54, v130
    v_sub_f32 v131, 1077936128, v6
    v_med3_f32 v131, v131, 0, 1.0
    v_mul_f32 v131, s54, v131
    v_sub_f32 v132, 1090519040, v6
    v_med3_f32 v132, v132, 0, 1.0
    v_mul_f32 v132, s54, v132
    v_sub_f32 v133, 1091567616, v6
    v_med3_f32 v133, v133, 0, 1.0
    v_mul_f32 v133, s54, v133
    v_sub_f32 v134, 1092616192, v6
    v_med3_f32 v134, v134, 0, 1.0
    v_mul_f32 v134, s54, v134
    v_sub_f32 v135, 1093664768, v6
    v_med3_f32 v135, v135, 0, 1.0
    v_mul_f32 v135, s54, v135
    v_sub_f32 v136, 1098907648, v6
    v_med3_f32 v136, v136, 0, 1.0
    v_mul_f32 v136, s54, v136
    v_sub_f32 v137, 1099431936, v6
    v_med3_f32 v137, v137, 0, 1.0
    v_mul_f32 v137, s54, v137
    v_sub_f32 v138, 1099956224, v6
    v_med3_f32 v138, v138, 0, 1.0
    v_mul_f32 v138, s54, v138
    v_sub_f32 v139, 1100480512, v6
    v_med3_f32 v139, v139, 0, 1.0
    v_mul_f32 v139, s54, v139
    v_sub_f32 v140, 1103101952, v6
    v_med3_f32 v140, v140, 0, 1.0
    v_mul_f32 v140, s54, v140
    v_sub_f32 v141, 1103626240, v6
    v_med3_f32 v141, v141, 0, 1.0
    v_mul_f32 v141, s54, v141
    v_sub_f32 v142, 1104150528, v6
    v_med3_f32 v142, v142, 0, 1.0
    v_mul_f32 v142, s54, v142
    v_sub_f32 v143, 1104674816, v6
    v_med3_f32 v143, v143, 0, 1.0
    v_mul_f32 v143, s54, v143
    ds_write_b128 v8, v[128:131] offset:0
    ds_write_b128 v8, v[132:135] offset:1024
    ds_write_b128 v8, v[136:139] offset:2048
    ds_write_b128 v8, v[140:143] offset:3072
    v_mov_b32 v1, 0x3f803f80
    v_mov_b32 v168, v1
    v_mov_b32 v169, v1
    v_mov_b32 v170, v1
    v_mov_b32 v171, v1
    v_mov_b32 v172, v1
    v_mov_b32 v173, v1
    v_mov_b32 v174, v1
    v_mov_b32 v175, v1
    v_mov_b32 v176, v1
    v_mov_b32 v177, v1
    v_mov_b32 v178, v1
    v_mov_b32 v179, v1
    v_mov_b32 v180, v1
    v_mov_b32 v181, v1
    v_mov_b32 v182, v1
    v_mov_b32 v183, v1
    v_mov_b32 v184, v1
    v_mov_b32 v185, v1
    v_mov_b32 v186, v1
    v_mov_b32 v187, v1
    v_mov_b32 v188, v1
    v_mov_b32 v189, v1
    v_mov_b32 v190, v1
    v_mov_b32 v191, v1
    v_mov_b32 v192, v1
    v_mov_b32 v193, v1
    v_mov_b32 v194, v1
    v_mov_b32 v195, v1
    v_mov_b32 v196, v1
    v_mov_b32 v197, v1
    v_mov_b32 v198, v1
    v_mov_b32 v199, v1
    v_mov_b32 v200, v1
    v_mov_b32 v201, v1
    v_mov_b32 v202, v1
    v_mov_b32 v203, v1
    v_mov_b32 v204, v1
    v_mov_b32 v205, v1
    v_mov_b32 v206, v1
    v_mov_b32 v207, v1
    v_mov_b32 v208, v1
    v_mov_b32 v209, v1
    v_mov_b32 v210, v1
    v_mov_b32 v211, v1
    v_mov_b32 v212, v1
    v_mov_b32 v213, v1
    v_mov_b32 v214, v1
    v_mov_b32 v215, v1
    s_lshl_b32 s64, s31, 7
    s_add_u32 s64, s64, 12582912
    s_add_u32 s38, s64, 64
    s_mov_b32 s62, 1052289595
    s_mov_b32 s67, 729808896
    s_mov_b32 s68, 1400897536
    s_mov_b32 s63, 0
    s_mov_b32 s54, 1
    s_waitcnt vmcnt(0)
L_gate:
    v_cmp_ne_u32 vcc, s54, v7
    s_nop 0
    s_cbranch_vccz L_gate_ok
    s_sleep 4
    buffer_load_dword v7, v13, s[24:27], 0 offen sc1
    s_add_u32 s63, s63, 1
    s_cmp_lt_u32 s63, 0x10000
    s_waitcnt vmcnt(0)
    s_cbranch_scc1 L_gate
L_gate_ok:
    s_and_b32 s54, s3, 3
    s_lshl_b32 s55, s54, 12
    s_add_u32 s55, s55, 70144
    v_lshlrev_b32 v2, 4, v0
    v_add_u32 v7, s55, v2
    v_and_b32 v11, 15, v0
    v_lshrrev_b32 v12, 5, v0
    v_lshl_or_b32 v11, v12, 4, v11
    v_lshlrev_b32 v3, 4, v11
    v_add_u32 v8, s55, v3
    v_add_u32 v3, 4096, v3
    s_lshl_b32 s33, s31, 2
    s_add_u32 s33, s33, s54
    s_lshl_b32 s33, s33, 13
    s_sub_u32 s34, s33, 524288
    s_sub_u32 s33, s33, 262144
    s_lshl_b32 s65, s31, 14
    s_lshl_b32 s55, s54, 10
    s_add_u32 s65, s65, s55
    s_add_u32 s65, s65, 8388608
    s_and_b32 s54, s3, 1
    s_lshl_b32 s55, s54, 10
    s_sub_u32 s55, s64, s55
    s_sub_u32 s55, s55, 1024
    v_mov_b32 v4, s55
    s_min_u32 s55, s29, 2
    s_lshr_b32 s51, s3, 1
    s_and_b32 s51, s51, 2
    s_xor_b32 s51, s51, s3
    s_and_b32 s51, s51, 3
    s_cmp_lt_u32 s51, s55
    s_cselect_b32 s50, 1, 0
    s_lshl_b32 s50, s50, s54
    s_mov_b32 s51, 1
    v_lshrrev_b32 v1, 3, v0
    v_and_b32 v5, 7, v0
    v_bfe_u32 v6, v0, 4, 1
    v_lshlrev_b32 v6, 2, v6
    v_xor_b32 v5, v5, v6
    v_lshlrev_b32 v5, 4, v5
    v_lshl_add_u32 v1, v1, 10, v5
    s_and_b32 s54, s3, 7
    s_lshl_b32 s48, s54, 13
    s_add_u32 s48, s48, 4608
    s_lshl_b32 s49, s54, 16
    s_lshl_b32 s54, s30, 7
    s_add_u32 s49, s49, s54
    s_cmp_eq_u32 s29, 0
    s_cselect_b32 s32, 1, 0
    s_mov_b32 s37, 0
    s_mul_i32 s54, s3, 4608
    s_add_u32 s54, s54, 122880
    v_add_u32 v5, s54, v2
    v_lshl_add_u32 v10, v0, 2, s54
    s_xor_b32 s54, s3, 4
    s_mul_i32 s54, s54, 4608
    s_add_u32 s54, s54, 122880
    v_add_u32 v6, s54, v2
    v_lshl_add_u32 v11, v0, 2, s54
    s_andn2_b32 s56, s31, 7
    s_add_u32 s56, s56, s3
    s_lshl_b32 s56, s56, 7
    s_add_u32 s56, s56, 12582976
    v_mov_b32 v9, s56
    v_mov_b32 v12, 0
    v_mov_b32 v32, 0
    v_mov_b32 v33, 0
    v_mov_b32 v34, 0
    v_mov_b32 v35, 0
    v_mov_b32 v36, 0
    v_mov_b32 v37, 0
    v_mov_b32 v38, 0
    v_mov_b32 v39, 0
    v_mov_b32 v40, 0
    v_mov_b32 v41, 0
    v_mov_b32 v42, 0
    v_mov_b32 v43, 0
    v_mov_b32 v44, 0
    v_mov_b32 v45, 0
    v_mov_b32 v46, 0
    v_mov_b32 v47, 0
    s_cmp_eq_u32 s50, 0
    s_cbranch_scc1 L_piy0
    s_mov_b64 exec, 1
    buffer_load_dword v15, v4, s[16:19], 0 offen sc1
    s_mov_b64 exec, -1
L_piy0:
    s_cmp_lg_u32 s32, 0
    s_cbranch_scc1 L_tl1a
    s_cmp_eq_u32 s50, 0
    s_cbranch_scc1 L_pck1a
    s_waitcnt vmcnt(0)
    v_readfirstlane_b32 s54, v15
    v_mov_b32 v14, s50
    s_cmp_lg_u32 s54, 1
    s_cbranch_scc1 L_pck1a
    s_mov_b64 exec, 1
    ds_or_b32 v12, v14 offset:4144
    s_mov_b64 exec, -1
    s_mov_b32 s50, 0
L_pck1a:
    ds_read_b32 v14, v12 offset:4144
    s_waitcnt lgkmcnt(0)
    v_readfirstlane_b32 s54, v14
    s_nop 0
    s_andn2_b32 s50, s50, s54
    s_cmp_eq_u32 s50, 0
    s_cbranch_scc1 L_pik1a
    s_mov_b64 exec, 1
    buffer_load_dword v15, v4, s[16:19], 0 offen sc1
    s_mov_b64 exec, -1
L_pik1a:
    s_and_b32 s54, s54, s51
    s_cmp_lg_u32 s54, s51
    s_cbranch_scc1 L_tl1a
    buffer_load_dwordx4 v[152:155], v2, s[16:19], s33 offen offset:1024 sc1
    s_mov_b64 exec, s[60:61]
    buffer_load_dwordx4 v[184:187], v3, s[16:19], s33 offen offset:1024 sc1
    buffer_load_dwordx4 v[188:191], v3, s[16:19], s33 offen offset:1536 sc1
    s_mov_b64 exec, -1
    buffer_load_dwordx4 v[156:159], v2, s[16:19], s33 offen offset:0 sc1
    s_mov_b64 exec, s[60:61]
    buffer_load_dwordx4 v[192:195], v3, s[16:19], s33 offen offset:0 sc1
    buffer_load_dwordx4 v[196:199], v3, s[16:19], s33 offen offset:512 sc1
    s_mov_b64 exec, -1
    s_mov_b32 s32, 1
    s_andn2_b32 s50, s50, s51
L_tl1a:
    s_waitcnt lgkmcnt(0)
    s_barrier
    ds_read_b128 v[16:19], v7 offset:32768
    ds_read_b128 v[20:23], v7 offset:33792
    ds_read_b128 v[24:27], v7 offset:34816
    ds_read_b128 v[28:31], v7 offset:35840
    ds_read_b128 v[144:147], v7 offset:1024
    ds_read_b128 v[148:151], v7 offset:2048
    ds_read_b128 v[128:131], v2 offset:0
    ds_read_b128 v[132:135], v2 offset:1024
    ds_read_b128 v[136:139], v2 offset:2048
    ds_read_b128 v[140:143], v2 offset:3072
    s_mov_b64 exec, s[60:61]
    ds_read_b128 v[168:171], v8 offset:17408
    ds_read_b128 v[172:175], v8 offset:17920
    ds_read_b128 v[176:179], v8 offset:18432
    ds_read_b128 v[180:183], v8 offset:18944
    s_mov_b64 exec, -1
    s_waitcnt lgkmcnt(4)
    v_mfma_f32_32x32x16_bf16 v[96:111], v[144:147], v[20:23], v[128:143]
    v_mfma_f32_32x32x16_bf16 v[112:127], v[144:147], v[24:27], 0
    s_nop 10
    v_exp_f32 v96, v96
    v_exp_f32 v97, v97
    v_exp_f32 v98, v98
    v_cvt_pk_bf16_f32 v96, v96, v97
    v_exp_f32 v99, v99
    v_exp_f32 v100, v100
    v_cvt_pk_bf16_f32 v97, v98, v99
    v_exp_f32 v101, v101
    v_exp_f32 v102, v102
    v_cvt_pk_bf16_f32 v98, v100, v101
    v_exp_f32 v103, v103
    v_exp_f32 v104, v104
    v_cvt_pk_bf16_f32 v99, v102, v103
    v_exp_f32 v105, v105
    v_exp_f32 v106, v106
    v_cvt_pk_bf16_f32 v104, v104, v105
    v_exp_f32 v107, v107
    s_waitcnt lgkmcnt(0)
    v_mfma_f32_32x32x16_bf16 v[48:63], v[168:171], v[96:99], 0
    v_exp_f32 v108, v108
    v_cvt_pk_bf16_f32 v105, v106, v107
    v_exp_f32 v109, v109
    v_exp_f32 v110, v110
    v_cvt_pk_bf16_f32 v106, v108, v109
    v_exp_f32 v111, v111
    s_nop 0
    v_cvt_pk_bf16_f32 v107, v110, v111
    v_exp_f32 v112, v112
    v_exp_f32 v113, v113
    v_mfma_f32_32x32x16_bf16 v[48:63], v[172:175], v[104:107], v[48:63]
    v_mfma_f32_32x32x16_bf16 v[96:111], v[144:147], v[28:31], 0
    v_exp_f32 v114, v114
    v_cvt_pk_bf16_f32 v112, v112, v113
    v_exp_f32 v115, v115
    v_exp_f32 v116, v116
    v_cvt_pk_bf16_f32 v113, v114, v115
    v_exp_f32 v117, v117
    v_exp_f32 v118, v118
    v_cvt_pk_bf16_f32 v114, v116, v117
    v_exp_f32 v119, v119
    v_exp_f32 v120, v120
    v_cvt_pk_bf16_f32 v115, v118, v119
    v_exp_f32 v121, v121
    v_exp_f32 v122, v122
    v_cvt_pk_bf16_f32 v120, v120, v121
    v_exp_f32 v123, v123
    v_mfma_f32_32x32x16_bf16 v[64:79], v[168:171], v[112:115], 0
    v_exp_f32 v124, v124
    v_cvt_pk_bf16_f32 v121, v122, v123
    v_exp_f32 v125, v125
    v_exp_f32 v126, v126
    v_cvt_pk_bf16_f32 v122, v124, v125
    v_exp_f32 v127, v127
    s_nop 0
    v_cvt_pk_bf16_f32 v123, v126, v127
    v_exp_f32 v96, v96
    v_exp_f32 v97, v97
    v_mfma_f32_32x32x16_bf16 v[64:79], v[172:175], v[120:123], v[64:79]
    v_mfma_f32_32x32x16_bf16 v[112:127], v[148:151], v[24:27], v[128:143]
    v_exp_f32 v98, v98
    v_cvt_pk_bf16_f32 v96, v96, v97
    v_exp_f32 v99, v99
    v_exp_f32 v100, v100
    v_cvt_pk_bf16_f32 v97, v98, v99
    v_exp_f32 v101, v101
    v_exp_f32 v102, v102
    v_cvt_pk_bf16_f32 v98, v100, v101
    v_exp_f32 v103, v103
    v_exp_f32 v104, v104
    v_cvt_pk_bf16_f32 v99, v102, v103
    v_exp_f32 v105, v105
    v_exp_f32 v106, v106
    v_cvt_pk_bf16_f32 v104, v104, v105
    v_exp_f32 v107, v107
    v_mfma_f32_32x32x16_bf16 v[80:95], v[168:171], v[96:99], 0
    v_exp_f32 v108, v108
    v_cvt_pk_bf16_f32 v105, v106, v107
    v_exp_f32 v109, v109
    v_exp_f32 v110, v110
    v_cvt_pk_bf16_f32 v106, v108, v109
    v_exp_f32 v111, v111
    s_nop 0
    v_cvt_pk_bf16_f32 v107, v110, v111
    s_cmp_eq_u32 s50, 0
    s_cbranch_scc1 L_piy3
    s_mov_b64 exec, 1
    buffer_load_dword v15, v4, s[16:19], 0 offen sc1
    s_mov_b64 exec, -1
L_piy3:
    v_exp_f32 v112, v112
    v_exp_f32 v113, v113
    v_mfma_f32_32x32x16_bf16 v[80:95], v[172:175], v[104:107], v[80:95]
    v_mfma_f32_32x32x16_bf16 v[96:111], v[148:151], v[28:31], 0
    v_exp_f32 v114, v114
    v_cvt_pk_bf16_f32 v112, v112, v113
    v_exp_f32 v115, v115
    v_exp_f32 v116, v116
    v_cvt_pk_bf16_f32 v113, v114, v115
    v_exp_f32 v117, v117
    v_exp_f32 v118, v118
    v_cvt_pk_bf16_f32 v114, v116, v117
    v_exp_f32 v119, v119
    v_exp_f32 v120, v120
    v_cvt_pk_bf16_f32 v115, v118, v119
    v_exp_f32 v121, v121
    v_exp_f32 v122, v122
    v_cvt_pk_bf16_f32 v120, v120, v121
    v_exp_f32 v123, v123
    v_mfma_f32_32x32x16_bf16 v[64:79], v[176:179], v[112:115], v[64:79]
    v_exp_f32 v124, v124
    v_cvt_pk_bf16_f32 v121, v122, v123
    v_exp_f32 v125, v125
    v_exp_f32 v126, v126
    v_cvt_pk_bf16_f32 v122, v124, v125
    v_exp_f32 v127, v127
    s_nop 0
    v_cvt_pk_bf16_f32 v123, v126, v127
    s_cmp_lg_u32 s32, 0
    s_cbranch_scc1 L_tl1m4
    s_cmp_eq_u32 s50, 0
    s_cbranch_scc1 L_pck1m4
    s_waitcnt vmcnt(0)
    v_readfirstlane_b32 s54, v15
    v_mov_b32 v14, s50
    s_cmp_lg_u32 s54, 1
    s_cbranch_scc1 L_pck1m4
    s_mov_b64 exec, 1
    ds_or_b32 v12, v14 offset:4144
    s_mov_b64 exec, -1
    s_mov_b32 s50, 0
L_pck1m4:
    ds_read_b32 v14, v12 offset:4144
    s_waitcnt lgkmcnt(0)
    v_readfirstlane_b32 s54, v14
    s_nop 0
    s_andn2_b32 s50, s50, s54
    s_cmp_eq_u32 s50, 0
    s_cbranch_scc1 L_pik1m4
    s_mov_b64 exec, 1
    buffer_load_dword v15, v4, s[16:19], 0 offen sc1
    s_mov_b64 exec, -1
L_pik1m4:
    s_and_b32 s54, s54, s51
    s_cmp_lg_u32 s54, s51
    s_cbranch_scc1 L_tl1m4
    buffer_load_dwordx4 v[152:155], v2, s[16:19], s33 offen offset:1024 sc1
    s_mov_b64 exec, s[60:61]
    buffer_load_dwordx4 v[184:187], v3, s[16:19], s33 offen offset:1024 sc1
    buffer_load_dwordx4 v[188:191], v3, s[16:19], s33 offen offset:1536 sc1
    s_mov_b64 exec, -1
    buffer_load_dwordx4 v[156:159], v2, s[16:19], s33 offen offset:0 sc1
    s_mov_b64 exec, s[60:61]
    buffer_load_dwordx4 v[192:195], v3, s[16:19], s33 offen offset:0 sc1
    buffer_load_dwordx4 v[196:199], v3, s[16:19], s33 offen offset:512 sc1
    s_mov_b64 exec, -1
    s_mov_b32 s32, 1
    s_andn2_b32 s50, s50, s51
L_tl1m4:
    v_exp_f32 v96, v96
    v_exp_f32 v97, v97
    v_mfma_f32_32x32x16_bf16 v[64:79], v[180:183], v[120:123], v[64:79]
    v_exp_f32 v98, v98
    v_cvt_pk_bf16_f32 v96, v96, v97
    v_exp_f32 v99, v99
    v_exp_f32 v100, v100
    v_cvt_pk_bf16_f32 v97, v98, v99
    v_exp_f32 v101, v101
    v_exp_f32 v102, v102
    v_cvt_pk_bf16_f32 v98, v100, v101
    v_exp_f32 v103, v103
    v_exp_f32 v104, v104
    v_cvt_pk_bf16_f32 v99, v102, v103
    v_exp_f32 v105, v105
    v_exp_f32 v106, v106
    v_cvt_pk_bf16_f32 v104, v104, v105
    v_exp_f32 v107, v107
    v_mfma_f32_32x32x16_bf16 v[80:95], v[176:179], v[96:99], v[80:95]
    v_exp_f32 v108, v108
    v_cvt_pk_bf16_f32 v105, v106, v107
    v_exp_f32 v109, v109
    v_exp_f32 v110, v110
    v_cvt_pk_bf16_f32 v106, v108, v109
    v_exp_f32 v111, v111
    s_nop 0
    v_cvt_pk_bf16_f32 v107, v110, v111
    s_nop 1
    v_mfma_f32_32x32x16_bf16 v[80:95], v[180:183], v[104:107], v[80:95]
    s_cmp_lg_u32 s32, 0
    s_cbranch_scc1 L_have1
    s_mov_b32 s63, 0
L_pkv1n:
    s_cmp_eq_u32 s50, 0
    s_cbranch_scc1 L_pck1bn
    s_waitcnt vmcnt(0)
    v_readfirstlane_b32 s54, v15
    v_mov_b32 v14, s50
    s_cmp_lg_u32 s54, 1
    s_cbranch_scc1 L_pck1bn
    s_mov_b64 exec, 1
    ds_or_b32 v12, v14 offset:4144
    s_mov_b64 exec, -1
    s_mov_b32 s50, 0
L_pck1bn:
    ds_read_b32 v14, v12 offset:4144
    s_waitcnt lgkmcnt(0)
    v_readfirstlane_b32 s54, v14
    s_nop 0
    s_andn2_b32 s50, s50, s54
    s_cmp_eq_u32 s50, 0
    s_cbranch_scc1 L_pik1bn
    s_mov_b64 exec, 1
    buffer_load_dword v15, v4, s[16:19], 0 offen sc1
    s_mov_b64 exec, -1
L_pik1bn:
    s_and_b32 s54, s54, s51
    s_cmp_eq_u32 s54, s51
    s_cbranch_scc1 L_pkv1n_ok
    s_add_u32 s63, s63, 1
    s_sleep 2
    s_cmp_lt_u32 s63, 0x40000
    s_cbranch_scc1 L_pkv1n
L_pkv1n_ok:
    buffer_load_dwordx4 v[152:155], v2, s[16:19], s33 offen offset:1024 sc1
    s_mov_b64 exec, s[60:61]
    buffer_load_dwordx4 v[184:187], v3, s[16:19], s33 offen offset:1024 sc1
    buffer_load_dwordx4 v[188:191], v3, s[16:19], s33 offen offset:1536 sc1
    s_mov_b64 exec, -1
    buffer_load_dwordx4 v[156:159], v2, s[16:19], s33 offen offset:0 sc1
    s_mov_b64 exec, s[60:61]
    buffer_load_dwordx4 v[192:195], v3, s[16:19], s33 offen offset:0 sc1
    buffer_load_dwordx4 v[196:199], v3, s[16:19], s33 offen offset:512 sc1
    s_mov_b64 exec, -1
    s_mov_b32 s32, 1
    s_andn2_b32 s50, s50, s51
L_have1:
    s_cmp_eq_u32 s29, 0
    s_cbranch_scc1 L_z1
    s_cmp_eq_u32 s29, 1
    s_cbranch_scc1 L_B1_only
    v_sub_f32 v128, 4048155338, v128
    v_sub_f32 v129, 4048155338, v129
    v_sub_f32 v130, 4048155338, v130
    v_sub_f32 v131, 4048155338, v131
    v_sub_f32 v132, 4048155338, v132
    v_sub_f32 v133, 4048155338, v133
    v_sub_f32 v134, 4048155338, v134
    v_sub_f32 v135, 4048155338, v135
    v_sub_f32 v136, 4048155338, v136
    v_sub_f32 v137, 4048155338, v137
    v_sub_f32 v138, 4048155338, v138
    v_sub_f32 v139, 4048155338, v139
    v_sub_f32 v140, 4048155338, v140
    v_sub_f32 v141, 4048155338, v141
    v_sub_f32 v142, 4048155338, v142
    v_sub_f32 v143, 4048155338, v143
    s_waitcnt vmcnt(3)
    v_mfma_f32_32x32x16_bf16 v[96:111], v[152:155], v[16:19], 0
    v_mfma_f32_32x32x16_bf16 v[112:127], v[152:155], v[20:23], 0
    s_nop 10
    v_exp_f32 v96, v96
    v_exp_f32 v97, v97
    v_exp_f32 v98, v98
    v_cvt_pk_bf16_f32 v96, v96, v97
    v_exp_f32 v99, v99
    v_exp_f32 v100, v100
    v_cvt_pk_bf16_f32 v97, v98, v99
    v_exp_f32 v101, v101
    v_exp_f32 v102, v102
    v_cvt_pk_bf16_f32 v98, v100, v101
    v_exp_f32 v103, v103
    v_exp_f32 v104, v104
    v_cvt_pk_bf16_f32 v99, v102, v103
    v_exp_f32 v105, v105
    v_exp_f32 v106, v106
    v_cvt_pk_bf16_f32 v104, v104, v105
    v_exp_f32 v107, v107
    v_mfma_f32_32x32x16_bf16 v[32:47], v[184:187], v[96:99], v[32:47]
    v_exp_f32 v108, v108
    v_cvt_pk_bf16_f32 v105, v106, v107
    v_exp_f32 v109, v109
    v_exp_f32 v110, v110
    v_cvt_pk_bf16_f32 v106, v108, v109
    v_exp_f32 v111, v111
    s_nop 0
    v_cvt_pk_bf16_f32 v107, v110, v111
    v_exp_f32 v112, v112
    v_exp_f32 v113, v113
    v_mfma_f32_32x32x16_bf16 v[32:47], v[188:191], v[104:107], v[32:47]
    v_mfma_f32_32x32x16_bf16 v[96:111], v[152:155], v[24:27], 0
    v_exp_f32 v114, v114
    v_cvt_pk_bf16_f32 v112, v112, v113
    v_exp_f32 v115, v115
    v_exp_f32 v116, v116
    v_cvt_pk_bf16_f32 v113, v114, v115
    v_exp_f32 v117, v117
    v_exp_f32 v118, v118
    v_cvt_pk_bf16_f32 v114, v116, v117
    v_exp_f32 v119, v119
    v_exp_f32 v120, v120
    v_cvt_pk_bf16_f32 v115, v118, v119
    v_exp_f32 v121, v121
    v_exp_f32 v122, v122
    v_cvt_pk_bf16_f32 v120, v120, v121
    v_exp_f32 v123, v123
    v_mfma_f32_32x32x16_bf16 v[48:63], v[184:187], v[112:115], v[48:63]
    v_exp_f32 v124, v124
    v_cvt_pk_bf16_f32 v121, v122, v123
    v_exp_f32 v125, v125
    v_exp_f32 v126, v126
    v_cvt_pk_bf16_f32 v122, v124, v125
    v_exp_f32 v127, v127
    s_nop 0
    v_cvt_pk_bf16_f32 v123, v126, v127
    s_mov_b32 s51, 2
    s_mov_b32 s63, 0
L_pkv1f:
    s_cmp_eq_u32 s50, 0
    s_cbranch_scc1 L_pck1bf
    s_waitcnt vmcnt(0)
    v_readfirstlane_b32 s54, v15
    v_mov_b32 v14, s50
    s_cmp_lg_u32 s54, 1
    s_cbranch_scc1 L_pck1bf
    s_mov_b64 exec, 1
    ds_or_b32 v12, v14 offset:4144
    s_mov_b64 exec, -1
    s_mov_b32 s50, 0
L_pck1bf:
    ds_read_b32 v14, v12 offset:4144
    s_waitcnt lgkmcnt(0)
    v_readfirstlane_b32 s54, v14
    s_nop 0
    s_andn2_b32 s50, s50, s54
    s_cmp_eq_u32 s50, 0
    s_cbranch_scc1 L_pik1bf
    s_mov_b64 exec, 1
    buffer_load_dword v15, v4, s[16:19], 0 offen sc1
    s_mov_b64 exec, -1
L_pik1bf:
    s_and_b32 s54, s54, s51
    s_cmp_eq_u32 s54, s51
    s_cbranch_scc1 L_pkv1f_ok
    s_add_u32 s63, s63, 1
    s_sleep 2
    s_cmp_lt_u32 s63, 0x40000
    s_cbranch_scc1 L_pkv1f
L_pkv1f_ok:
    buffer_load_dwordx4 v[160:163], v2, s[16:19], s34 offen offset:2048 sc1
    s_mov_b64 exec, s[60:61]
    buffer_load_dwordx4 v[200:203], v3, s[16:19], s34 offen offset:2048 sc1
    buffer_load_dwordx4 v[204:207], v3, s[16:19], s34 offen offset:2560 sc1
    s_mov_b64 exec, -1
    buffer_load_dwordx4 v[164:167], v2, s[16:19], s34 offen offset:1024 sc1
    s_mov_b64 exec, s[60:61]
    buffer_load_dwordx4 v[208:211], v3, s[16:19], s34 offen offset:1024 sc1
    buffer_load_dwordx4 v[212:215], v3, s[16:19], s34 offen offset:1536 sc1
    s_mov_b64 exec, -1
    s_mov_b32 s32, 1
    s_andn2_b32 s50, s50, s51
    v_exp_f32 v96, v96
    v_exp_f32 v97, v97
    v_mfma_f32_32x32x16_bf16 v[48:63], v[188:191], v[120:123], v[48:63]
    v_mfma_f32_32x32x16_bf16 v[112:127], v[152:155], v[28:31], 0
    v_exp_f32 v98, v98
    v_cvt_pk_bf16_f32 v96, v96, v97
    v_exp_f32 v99, v99
    v_exp_f32 v100, v100
    v_cvt_pk_bf16_f32 v97, v98, v99
    v_exp_f32 v101, v101
    v_exp_f32 v102, v102
    v_cvt_pk_bf16_f32 v98, v100, v101
    v_exp_f32 v103, v103
    v_exp_f32 v104, v104
    v_cvt_pk_bf16_f32 v99, v102, v103
    v_exp_f32 v105, v105
    v_exp_f32 v106, v106
    v_cvt_pk_bf16_f32 v104, v104, v105
    v_exp_f32 v107, v107
    v_mfma_f32_32x32x16_bf16 v[64:79], v[184:187], v[96:99], v[64:79]
    v_exp_f32 v108, v108
    v_cvt_pk_bf16_f32 v105, v106, v107
    v_exp_f32 v109, v109
    v_exp_f32 v110, v110
    v_cvt_pk_bf16_f32 v106, v108, v109
    v_exp_f32 v111, v111
    s_nop 0
    v_cvt_pk_bf16_f32 v107, v110, v111
    v_exp_f32 v112, v112
    v_exp_f32 v113, v113
    v_mfma_f32_32x32x16_bf16 v[64:79], v[188:191], v[104:107], v[64:79]
    s_waitcnt vmcnt(6)
    v_mfma_f32_32x32x16_bf16 v[96:111], v[156:159], v[16:19], 0
    v_exp_f32 v114, v114
    v_cvt_pk_bf16_f32 v112, v112, v113
    v_exp_f32 v115, v115
    v_exp_f32 v116, v116
    v_cvt_pk_bf16_f32 v113, v114, v115
    v_exp_f32 v117, v117
    v_exp_f32 v118, v118
    v_cvt_pk_bf16_f32 v114, v116, v117
    v_exp_f32 v119, v119
    v_exp_f32 v120, v120
    v_cvt_pk_bf16_f32 v115, v118, v119
    v_exp_f32 v121, v121
    v_exp_f32 v122, v122
    v_cvt_pk_bf16_f32 v120, v120, v121
    v_exp_f32 v123, v123
    v_mfma_f32_32x32x16_bf16 v[80:95], v[184:187], v[112:115], v[80:95]
    v_exp_f32 v124, v124
    v_cvt_pk_bf16_f32 v121, v122, v123
    v_exp_f32 v125, v125
    v_exp_f32 v126, v126
    v_cvt_pk_bf16_f32 v122, v124, v125
    v_exp_f32 v127, v127
    s_nop 0
    v_cvt_pk_bf16_f32 v123, v126, v127
    s_add_u32 m0, s48, 0
    s_add_u32 s54, s49, 0
    buffer_load_dwordx4 v1, s[12:15], s54 offen lds
    s_setprio 1
    v_exp_f32 v96, v96
    v_exp_f32 v97, v97
    v_mfma_f32_32x32x16_bf16 v[80:95], v[188:191], v[120:123], v[80:95]
    v_mfma_f32_32x32x16_bf16 v[112:127], v[156:159], v[20:23], 0
    v_exp_f32 v98, v98
    v_cvt_pk_bf16_f32 v96, v96, v97
    v_exp_f32 v99, v99
    v_exp_f32 v100, v100
    v_cvt_pk_bf16_f32 v97, v98, v99
    v_exp_f32 v101, v101
    v_exp_f32 v102, v102
    v_cvt_pk_bf16_f32 v98, v100, v101
    v_exp_f32 v103, v103
    v_exp_f32 v104, v104
    v_cvt_pk_bf16_f32 v99, v102, v103
    v_exp_f32 v105, v105
    v_exp_f32 v106, v106
    v_cvt_pk_bf16_f32 v104, v104, v105
    v_exp_f32 v107, v107
    v_mfma_f32_32x32x16_bf16 v[32:47], v[192:195], v[96:99], v[32:47]
    v_exp_f32 v108, v108
    v_cvt_pk_bf16_f32 v105, v106, v107
    v_exp_f32 v109, v109
    v_exp_f32 v110, v110
    v_cvt_pk_bf16_f32 v106, v108, v109
    v_exp_f32 v111, v111
    s_nop 0
    v_cvt_pk_bf16_f32 v107, v110, v111
    s_add_u32 m0, s48, 1024
    s_add_u32 s54, s49, 8192
    buffer_load_dwordx4 v1, s[12:15], s54 offen lds
    v_exp_f32 v112, v112
    v_exp_f32 v113, v113
    v_mfma_f32_32x32x16_bf16 v[32:47], v[196:199], v[104:107], v[32:47]
    v_mfma_f32_32x32x16_bf16 v[96:111], v[156:159], v[24:27], 0
    v_exp_f32 v114, v114
    v_cvt_pk_bf16_f32 v112, v112, v113
    v_exp_f32 v115, v115
    v_exp_f32 v116, v116
    v_cvt_pk_bf16_f32 v113, v114, v115
    v_exp_f32 v117, v117
    v_exp_f32 v118, v118
    v_cvt_pk_bf16_f32 v114, v116, v117
    v_exp_f32 v119, v119
    v_exp_f32 v120, v120
    v_cvt_pk_bf16_f32 v115, v118, v119
    v_exp_f32 v121, v121
    v_exp_f32 v122, v122
    v_cvt_pk_bf16_f32 v120, v120, v121
    v_exp_f32 v123, v123
    v_mfma_f32_32x32x16_bf16 v[48:63], v[192:195], v[112:115], v[48:63]
    v_exp_f32 v124, v124
    v_cvt_pk_bf16_f32 v121, v122, v123
    v_exp_f32 v125, v125
    v_exp_f32 v126, v126
    v_cvt_pk_bf16_f32 v122, v124, v125
    v_exp_f32 v127, v127
    s_nop 0
    v_cvt_pk_bf16_f32 v123, v126, v127
    s_add_u32 m0, s48, 2048
    s_add_u32 s54, s49, 16384
    buffer_load_dwordx4 v1, s[12:15], s54 offen lds
    v_exp_f32 v96, v96
    v_exp_f32 v97, v97
    v_mfma_f32_32x32x16_bf16 v[48:63], v[196:199], v[120:123], v[48:63]
    v_mfma_f32_32x32x16_bf16 v[112:127], v[156:159], v[28:31], 0
    v_exp_f32 v98, v98
    v_cvt_pk_bf16_f32 v96, v96, v97
    v_exp_f32 v99, v99
    v_exp_f32 v100, v100
    v_cvt_pk_bf16_f32 v97, v98, v99
    v_exp_f32 v101, v101
    v_exp_f32 v102, v102
    v_cvt_pk_bf16_f32 v98, v100, v101
    v_exp_f32 v103, v103
    v_exp_f32 v104, v104
    v_cvt_pk_bf16_f32 v99, v102, v103
    v_exp_f32 v105, v105
    v_exp_f32 v106, v106
    v_cvt_pk_bf16_f32 v104, v104, v105
    v_exp_f32 v107, v107
    v_mfma_f32_32x32x16_bf16 v[64:79], v[192:195], v[96:99], v[64:79]
    v_exp_f32 v108, v108
    v_cvt_pk_bf16_f32 v105, v106, v107
    v_exp_f32 v109, v109
    v_exp_f32 v110, v110
    v_cvt_pk_bf16_f32 v106, v108, v109
    v_exp_f32 v111, v111
    s_nop 0
    v_cvt_pk_bf16_f32 v107, v110, v111
    s_add_u32 m0, s48, 3072
    s_add_u32 s54, s49, 24576
    buffer_load_dwordx4 v1, s[12:15], s54 offen lds
    v_exp_f32 v112, v112
    v_exp_f32 v113, v113
    v_mfma_f32_32x32x16_bf16 v[64:79], v[196:199], v[104:107], v[64:79]
    s_waitcnt vmcnt(7)
    v_mfma_f32_32x32x16_bf16 v[96:111], v[160:163], v[16:19], 0
    v_exp_f32 v114, v114
    v_cvt_pk_bf16_f32 v112, v112, v113
    v_exp_f32 v115, v115
    v_exp_f32 v116, v116
    v_cvt_pk_bf16_f32 v113, v114, v115
    v_exp_f32 v117, v117
    v_exp_f32 v118, v118
    v_cvt_pk_bf16_f32 v114, v116, v117
    v_exp_f32 v119, v119
    v_exp_f32 v120, v120
    v_cvt_pk_bf16_f32 v115, v118, v119
    v_exp_f32 v121, v121
    v_exp_f32 v122, v122
    v_cvt_pk_bf16_f32 v120, v120, v121
    v_exp_f32 v123, v123
    v_mfma_f32_32x32x16_bf16 v[80:95], v[192:195], v[112:115], v[80:95]
    v_exp_f32 v124, v124
    v_cvt_pk_bf16_f32 v121, v122, v123
    v_exp_f32 v125, v125
    v_exp_f32 v126, v126
    v_cvt_pk_bf16_f32 v122, v124, v125
    v_exp_f32 v127, v127
    s_nop 0
    v_cvt_pk_bf16_f32 v123, v126, v127
    s_add_u32 m0, s48, 4096
    s_add_u32 s54, s49, 32768
    buffer_load_dwordx4 v1, s[12:15], s54 offen lds
    v_exp_f32 v96, v96
    v_exp_f32 v97, v97
    v_mfma_f32_32x32x16_bf16 v[80:95], v[196:199], v[120:123], v[80:95]
    v_mfma_f32_32x32x16_bf16 v[112:127], v[160:163], v[20:23], 0
    v_exp_f32 v98, v98
    v_cvt_pk_bf16_f32 v96, v96, v97
    v_exp_f32 v99, v99
    v_exp_f32 v100, v100
    v_cvt_pk_bf16_f32 v97, v98, v99
    v_exp_f32 v101, v101
    v_exp_f32 v102, v102
    v_cvt_pk_bf16_f32 v98, v100, v101
    v_exp_f32 v103, v103
    v_exp_f32 v104, v104
    v_cvt_pk_bf16_f32 v99, v102, v103
    v_exp_f32 v105, v105
    v_exp_f32 v106, v106
    v_cvt_pk_bf16_f32 v104, v104, v105
    v_exp_f32 v107, v107
    v_mfma_f32_32x32x16_bf16 v[32:47], v[200:203], v[96:99], v[32:47]
    v_exp_f32 v108, v108
    v_cvt_pk_bf16_f32 v105, v106, v107
    v_exp_f32 v109, v109
    v_exp_f32 v110, v110
    v_cvt_pk_bf16_f32 v106, v108, v109
    v_exp_f32 v111, v111
    s_nop 0
    v_cvt_pk_bf16_f32 v107, v110, v111
    s_add_u32 m0, s48, 5120
    s_add_u32 s54, s49, 40960
    buffer_load_dwordx4 v1, s[12:15], s54 offen lds
    v_exp_f32 v112, v112
    v_exp_f32 v113, v113
    v_mfma_f32_32x32x16_bf16 v[32:47], v[204:207], v[104:107], v[32:47]
    v_mfma_f32_32x32x16_bf16 v[96:111], v[160:163], v[24:27], v[128:143]
    v_exp_f32 v114, v114
    v_cvt_pk_bf16_f32 v112, v112, v113
    v_exp_f32 v115, v115
    v_exp_f32 v116, v116
    v_cvt_pk_bf16_f32 v113, v114, v115
    v_exp_f32 v117, v117
    v_exp_f32 v118, v118
    v_cvt_pk_bf16_f32 v114, v116, v117
    v_exp_f32 v119, v119
    v_exp_f32 v120, v120
    v_cvt_pk_bf16_f32 v115, v118, v119
    v_exp_f32 v121, v121
    v_exp_f32 v122, v122
    v_cvt_pk_bf16_f32 v120, v120, v121
    v_exp_f32 v123, v123
    v_mfma_f32_32x32x16_bf16 v[48:63], v[200:203], v[112:115], v[48:63]
    v_exp_f32 v124, v124
    v_cvt_pk_bf16_f32 v121, v122, v123
    v_exp_f32 v125, v125
    v_exp_f32 v126, v126
    v_cvt_pk_bf16_f32 v122, v124, v125
    v_exp_f32 v127, v127
    s_nop 0
    v_cvt_pk_bf16_f32 v123, v126, v127
    s_add_u32 m0, s48, 6144
    s_add_u32 s54, s49, 49152
    buffer_load_dwordx4 v1, s[12:15], s54 offen lds
    s_setprio 0
    v_exp_f32 v96, v96
    v_exp_f32 v97, v97
    v_mfma_f32_32x32x16_bf16 v[48:63], v[204:207], v[120:123], v[48:63]
    s_waitcnt vmcnt(7)
    v_mfma_f32_32x32x16_bf16 v[112:127], v[164:167], v[16:19], 0
    v_exp_f32 v98, v98
    v_cvt_pk_bf16_f32 v96, v96, v97
    v_exp_f32 v99, v99
    v_exp_f32 v100, v100
    v_cvt_pk_bf16_f32 v97, v98, v99
    v_exp_f32 v101, v101
    v_exp_f32 v102, v102
    v_cvt_pk_bf16_f32 v98, v100, v101
    v_exp_f32 v103, v103
    v_exp_f32 v104, v104
    v_cvt_pk_bf16_f32 v99, v102, v103
    v_exp_f32 v105, v105
    v_exp_f32 v106, v106
    v_cvt_pk_bf16_f32 v104, v104, v105
    v_exp_f32 v107, v107
    v_mfma_f32_32x32x16_bf16 v[64:79], v[200:203], v[96:99], v[64:79]
    v_exp_f32 v108, v108
    v_cvt_pk_bf16_f32 v105, v106, v107
    v_exp_f32 v109, v109
    v_exp_f32 v110, v110
    v_cvt_pk_bf16_f32 v106, v108, v109
    v_exp_f32 v111, v111
    s_nop 0
    v_cvt_pk_bf16_f32 v107, v110, v111
    s_add_u32 m0, s48, 7168
    s_add_u32 s54, s49, 57344
    buffer_load_dwordx4 v1, s[12:15], s54 offen lds
    v_exp_f32 v112, v112
    v_exp_f32 v113, v113
    v_mfma_f32_32x32x16_bf16 v[64:79], v[204:207], v[104:107], v[64:79]
    v_mfma_f32_32x32x16_bf16 v[96:111], v[164:167], v[20:23], v[128:143]
    v_exp_f32 v114, v114
    v_cvt_pk_bf16_f32 v112, v112, v113
    v_exp_f32 v115, v115
    v_exp_f32 v116, v116
    v_cvt_pk_bf16_f32 v113, v114, v115
    v_exp_f32 v117, v117
    v_exp_f32 v118, v118
    v_cvt_pk_bf16_f32 v114, v116, v117
    v_exp_f32 v119, v119
    v_exp_f32 v120, v120
    v_cvt_pk_bf16_f32 v115, v118, v119
    v_exp_f32 v121, v121
    v_exp_f32 v122, v122
    v_cvt_pk_bf16_f32 v120, v120, v121
    v_exp_f32 v123, v123
    v_mfma_f32_32x32x16_bf16 v[32:47], v[208:211], v[112:115], v[32:47]
    v_exp_f32 v124, v124
    v_cvt_pk_bf16_f32 v121, v122, v123
    v_exp_f32 v125, v125
    v_exp_f32 v126, v126
    v_cvt_pk_bf16_f32 v122, v124, v125
    v_exp_f32 v127, v127
    s_nop 0
    v_cvt_pk_bf16_f32 v123, v126, v127
    v_exp_f32 v96, v96
    v_exp_f32 v97, v97
    v_mfma_f32_32x32x16_bf16 v[32:47], v[212:215], v[120:123], v[32:47]
    v_exp_f32 v98, v98
    v_cvt_pk_bf16_f32 v96, v96, v97
    v_exp_f32 v99, v99
    v_exp_f32 v100, v100
    v_cvt_pk_bf16_f32 v97, v98, v99
    v_exp_f32 v101, v101
    v_exp_f32 v102, v102
    v_cvt_pk_bf16_f32 v98, v100, v101
    v_exp_f32 v103, v103
    v_exp_f32 v104, v104
    v_cvt_pk_bf16_f32 v99, v102, v103
    v_exp_f32 v105, v105
    v_exp_f32 v106, v106
    v_cvt_pk_bf16_f32 v104, v104, v105
    v_exp_f32 v107, v107
    v_mfma_f32_32x32x16_bf16 v[48:63], v[208:211], v[96:99], v[48:63]
    v_exp_f32 v108, v108
    v_cvt_pk_bf16_f32 v105, v106, v107
    v_exp_f32 v109, v109
    v_exp_f32 v110, v110
    v_cvt_pk_bf16_f32 v106, v108, v109
    v_exp_f32 v111, v111
    s_nop 0
    v_cvt_pk_bf16_f32 v107, v110, v111
    s_nop 1
    v_mfma_f32_32x32x16_bf16 v[48:63], v[212:215], v[104:107], v[48:63]
    s_branch L_fin1
L_z1:
    s_add_u32 m0, s48, 0
    s_add_u32 s54, s49, 0
    buffer_load_dwordx4 v1, s[12:15], s54 offen lds
    s_add_u32 m0, s48, 1024
    s_add_u32 s54, s49, 8192
    buffer_load_dwordx4 v1, s[12:15], s54 offen lds
    s_add_u32 m0, s48, 2048
    s_add_u32 s54, s49, 16384
    buffer_load_dwordx4 v1, s[12:15], s54 offen lds
    s_add_u32 m0, s48, 3072
    s_add_u32 s54, s49, 24576
    buffer_load_dwordx4 v1, s[12:15], s54 offen lds
    s_add_u32 m0, s48, 4096
    s_add_u32 s54, s49, 32768
    buffer_load_dwordx4 v1, s[12:15], s54 offen lds
    s_add_u32 m0, s48, 5120
    s_add_u32 s54, s49, 40960
    buffer_load_dwordx4 v1, s[12:15], s54 offen lds
    s_add_u32 m0, s48, 6144
    s_add_u32 s54, s49, 49152
    buffer_load_dwordx4 v1, s[12:15], s54 offen lds
    s_add_u32 m0, s48, 7168
    s_add_u32 s54, s49, 57344
    buffer_load_dwordx4 v1, s[12:15], s54 offen lds
    s_branch L_fin1
L_B1_only:
    s_waitcnt vmcnt(3)
    v_mfma_f32_32x32x16_bf16 v[96:111], v[152:155], v[16:19], 0
    v_mfma_f32_32x32x16_bf16 v[112:127], v[152:155], v[20:23], 0
    s_add_u32 m0, s48, 0
    s_add_u32 s54, s49, 0
    buffer_load_dwordx4 v1, s[12:15], s54 offen lds
    s_setprio 1
    s_nop 6
    v_exp_f32 v96, v96
    v_exp_f32 v97, v97
    v_exp_f32 v98, v98
    v_cvt_pk_bf16_f32 v96, v96, v97
    v_exp_f32 v99, v99
    v_exp_f32 v100, v100
    v_cvt_pk_bf16_f32 v97, v98, v99
    v_exp_f32 v101, v101
    v_exp_f32 v102, v102
    v_cvt_pk_bf16_f32 v98, v100, v101
    v_exp_f32 v103, v103
    v_exp_f32 v104, v104
    v_cvt_pk_bf16_f32 v99, v102, v103
    v_exp_f32 v105, v105
    v_exp_f32 v106, v106
    v_cvt_pk_bf16_f32 v104, v104, v105
    v_exp_f32 v107, v107
    v_mfma_f32_32x32x16_bf16 v[32:47], v[184:187], v[96:99], v[32:47]
    v_exp_f32 v108, v108
    v_cvt_pk_bf16_f32 v105, v106, v107
    v_exp_f32 v109, v109
    v_exp_f32 v110, v110
    v_cvt_pk_bf16_f32 v106, v108, v109
    v_exp_f32 v111, v111
    s_nop 0
    v_cvt_pk_bf16_f32 v107, v110, v111
    s_add_u32 m0, s48, 1024
    s_add_u32 s54, s49, 8192
    buffer_load_dwordx4 v1, s[12:15], s54 offen lds
    v_exp_f32 v112, v112
    v_exp_f32 v113, v113
    v_mfma_f32_32x32x16_bf16 v[32:47], v[188:191], v[104:107], v[32:47]
    v_mfma_f32_32x32x16_bf16 v[96:111], v[152:155], v[24:27], 0
    v_exp_f32 v114, v114
    v_cvt_pk_bf16_f32 v112, v112, v113
    v_exp_f32 v115, v115
    v_exp_f32 v116, v116
    v_cvt_pk_bf16_f32 v113, v114, v115
    v_exp_f32 v117, v117
    v_exp_f32 v118, v118
    v_cvt_pk_bf16_f32 v114, v116, v117
    v_exp_f32 v119, v119
    v_exp_f32 v120, v120
    v_cvt_pk_bf16_f32 v115, v118, v119
    v_exp_f32 v121, v121
    v_exp_f32 v122, v122
    v_cvt_pk_bf16_f32 v120, v120, v121
    v_exp_f32 v123, v123
    v_mfma_f32_32x32x16_bf16 v[48:63], v[184:187], v[112:115], v[48:63]
    v_exp_f32 v124, v124
    v_cvt_pk_bf16_f32 v121, v122, v123
    v_exp_f32 v125, v125
    v_exp_f32 v126, v126
    v_cvt_pk_bf16_f32 v122, v124, v125
    v_exp_f32 v127, v127
    s_nop 0
    v_cvt_pk_bf16_f32 v123, v126, v127
    s_add_u32 m0, s48, 2048
    s_add_u32 s54, s49, 16384
    buffer_load_dwordx4 v1, s[12:15], s54 offen lds
    v_exp_f32 v96, v96
    v_exp_f32 v97, v97
    v_mfma_f32_32x32x16_bf16 v[48:63], v[188:191], v[120:123], v[48:63]
    v_mfma_f32_32x32x16_bf16 v[112:127], v[152:155], v[28:31], 0
    v_exp_f32 v98, v98
    v_cvt_pk_bf16_f32 v96, v96, v97
    v_exp_f32 v99, v99
    v_exp_f32 v100, v100
    v_cvt_pk_bf16_f32 v97, v98, v99
    v_exp_f32 v101, v101
    v_exp_f32 v102, v102
    v_cvt_pk_bf16_f32 v98, v100, v101
    v_exp_f32 v103, v103
    v_exp_f32 v104, v104
    v_cvt_pk_bf16_f32 v99, v102, v103
    v_exp_f32 v105, v105
    v_exp_f32 v106, v106
    v_cvt_pk_bf16_f32 v104, v104, v105
    v_exp_f32 v107, v107
    v_mfma_f32_32x32x16_bf16 v[64:79], v[184:187], v[96:99], v[64:79]
    v_exp_f32 v108, v108
    v_cvt_pk_bf16_f32 v105, v106, v107
    v_exp_f32 v109, v109
    v_exp_f32 v110, v110
    v_cvt_pk_bf16_f32 v106, v108, v109
    v_exp_f32 v111, v111
    s_nop 0
    v_cvt_pk_bf16_f32 v107, v110, v111
    s_add_u32 m0, s48, 3072
    s_add_u32 s54, s49, 24576
    buffer_load_dwordx4 v1, s[12:15], s54 offen lds
    v_exp_f32 v112, v112
    v_exp_f32 v113, v113
    v_mfma_f32_32x32x16_bf16 v[64:79], v[188:191], v[104:107], v[64:79]
    s_waitcnt vmcnt(4)
    v_mfma_f32_32x32x16_bf16 v[96:111], v[156:159], v[16:19], 0
    v_exp_f32 v114, v114
    v_cvt_pk_bf16_f32 v112, v112, v113
    v_exp_f32 v115, v115
    v_exp_f32 v116, v116
    v_cvt_pk_bf16_f32 v113, v114, v115
    v_exp_f32 v117, v117
    v_exp_f32 v118, v118
    v_cvt_pk_bf16_f32 v114, v116, v117
    v_exp_f32 v119, v119
    v_exp_f32 v120, v120
    v_cvt_pk_bf16_f32 v115, v118, v119
    v_exp_f32 v121, v121
    v_exp_f32 v122, v122
    v_cvt_pk_bf16_f32 v120, v120, v121
    v_exp_f32 v123, v123
    v_mfma_f32_32x32x16_bf16 v[80:95], v[184:187], v[112:115], v[80:95]
    v_exp_f32 v124, v124
    v_cvt_pk_bf16_f32 v121, v122, v123
    v_exp_f32 v125, v125
    v_exp_f32 v126, v126
    v_cvt_pk_bf16_f32 v122, v124, v125
    v_exp_f32 v127, v127
    s_nop 0
    v_cvt_pk_bf16_f32 v123, v126, v127
    s_add_u32 m0, s48, 4096
    s_add_u32 s54, s49, 32768
    buffer_load_dwordx4 v1, s[12:15], s54 offen lds
    v_exp_f32 v96, v96
    v_exp_f32 v97, v97
    v_mfma_f32_32x32x16_bf16 v[80:95], v[188:191], v[120:123], v[80:95]
    v_mfma_f32_32x32x16_bf16 v[112:127], v[156:159], v[20:23], 0
    v_exp_f32 v98, v98
    v_cvt_pk_bf16_f32 v96, v96, v97
    v_exp_f32 v99, v99
    v_exp_f32 v100, v100
    v_cvt_pk_bf16_f32 v97, v98, v99
    v_exp_f32 v101, v101
    v_exp_f32 v102, v102
    v_cvt_pk_bf16_f32 v98, v100, v101
    v_exp_f32 v103, v103
    v_exp_f32 v104, v104
    v_cvt_pk_bf16_f32 v99, v102, v103
    v_exp_f32 v105, v105
    v_exp_f32 v106, v106
    v_cvt_pk_bf16_f32 v104, v104, v105
    v_exp_f32 v107, v107
    v_mfma_f32_32x32x16_bf16 v[32:47], v[192:195], v[96:99], v[32:47]
    v_exp_f32 v108, v108
    v_cvt_pk_bf16_f32 v105, v106, v107
    v_exp_f32 v109, v109
    v_exp_f32 v110, v110
    v_cvt_pk_bf16_f32 v106, v108, v109
    v_exp_f32 v111, v111
    s_nop 0
    v_cvt_pk_bf16_f32 v107, v110, v111
    s_add_u32 m0, s48, 5120
    s_add_u32 s54, s49, 40960
    buffer_load_dwordx4 v1, s[12:15], s54 offen lds
    v_exp_f32 v112, v112
    v_exp_f32 v113, v113
    v_mfma_f32_32x32x16_bf16 v[32:47], v[196:199], v[104:107], v[32:47]
    v_mfma_f32_32x32x16_bf16 v[96:111], v[156:159], v[24:27], 0
    v_exp_f32 v114, v114
    v_cvt_pk_bf16_f32 v112, v112, v113
    v_exp_f32 v115, v115
    v_exp_f32 v116, v116
    v_cvt_pk_bf16_f32 v113, v114, v115
    v_exp_f32 v117, v117
    v_exp_f32 v118, v118
    v_cvt_pk_bf16_f32 v114, v116, v117
    v_exp_f32 v119, v119
    v_exp_f32 v120, v120
    v_cvt_pk_bf16_f32 v115, v118, v119
    v_exp_f32 v121, v121
    v_exp_f32 v122, v122
    v_cvt_pk_bf16_f32 v120, v120, v121
    v_exp_f32 v123, v123
    v_mfma_f32_32x32x16_bf16 v[48:63], v[192:195], v[112:115], v[48:63]
    v_exp_f32 v124, v124
    v_cvt_pk_bf16_f32 v121, v122, v123
    v_exp_f32 v125, v125
    v_exp_f32 v126, v126
    v_cvt_pk_bf16_f32 v122, v124, v125
    v_exp_f32 v127, v127
    s_nop 0
    v_cvt_pk_bf16_f32 v123, v126, v127
    s_add_u32 m0, s48, 6144
    s_add_u32 s54, s49, 49152
    buffer_load_dwordx4 v1, s[12:15], s54 offen lds
    s_setprio 0
    v_exp_f32 v96, v96
    v_exp_f32 v97, v97
    v_mfma_f32_32x32x16_bf16 v[48:63], v[196:199], v[120:123], v[48:63]
    v_mfma_f32_32x32x16_bf16 v[112:127], v[156:159], v[28:31], 0
    v_exp_f32 v98, v98
    v_cvt_pk_bf16_f32 v96, v96, v97
    v_exp_f32 v99, v99
    v_exp_f32 v100, v100
    v_cvt_pk_bf16_f32 v97, v98, v99
    v_exp_f32 v101, v101
    v_exp_f32 v102, v102
    v_cvt_pk_bf16_f32 v98, v100, v101
    v_exp_f32 v103, v103
    v_exp_f32 v104, v104
    v_cvt_pk_bf16_f32 v99, v102, v103
    v_exp_f32 v105, v105
    v_exp_f32 v106, v106
    v_cvt_pk_bf16_f32 v104, v104, v105
    v_exp_f32 v107, v107
    v_mfma_f32_32x32x16_bf16 v[64:79], v[192:195], v[96:99], v[64:79]
    v_exp_f32 v108, v108
    v_cvt_pk_bf16_f32 v105, v106, v107
    v_exp_f32 v109, v109
    v_exp_f32 v110, v110
    v_cvt_pk_bf16_f32 v106, v108, v109
    v_exp_f32 v111, v111
    s_nop 0
    v_cvt_pk_bf16_f32 v107, v110, v111
    s_add_u32 m0, s48, 7168
    s_add_u32 s54, s49, 57344
    buffer_load_dwordx4 v1, s[12:15], s54 offen lds
    v_exp_f32 v112, v112
    v_exp_f32 v113, v113
    v_mfma_f32_32x32x16_bf16 v[64:79], v[196:199], v[104:107], v[64:79]
    v_exp_f32 v114, v114
    v_cvt_pk_bf16_f32 v112, v112, v113
    v_exp_f32 v115, v115
    v_exp_f32 v116, v116
    v_cvt_pk_bf16_f32 v113, v114, v115
    v_exp_f32 v117, v117
    v_exp_f32 v118, v118
    v_cvt_pk_bf16_f32 v114, v116, v117
    v_exp_f32 v119, v119
    v_exp_f32 v120, v120
    v_cvt_pk_bf16_f32 v115, v118, v119
    v_exp_f32 v121, v121
    v_exp_f32 v122, v122
    v_cvt_pk_bf16_f32 v120, v120, v121
    v_exp_f32 v123, v123
    v_mfma_f32_32x32x16_bf16 v[80:95], v[192:195], v[112:115], v[80:95]
    v_exp_f32 v124, v124
    v_cvt_pk_bf16_f32 v121, v122, v123
    v_exp_f32 v125, v125
    v_exp_f32 v126, v126
    v_cvt_pk_bf16_f32 v122, v124, v125
    v_exp_f32 v127, v127
    s_nop 0
    v_cvt_pk_bf16_f32 v123, v126, v127
    s_nop 1
    v_mfma_f32_32x32x16_bf16 v[80:95], v[196:199], v[120:123], v[80:95]
L_fin1:
    s_setprio 0
    s_nop 10
    ds_write_b128 v5, v[32:35] offset:0
    ds_write_b128 v5, v[36:39] offset:1024
    ds_write_b32 v10, v40 offset:4096
    ds_write_b128 v5, v[48:51] offset:2048
    ds_write_b128 v5, v[52:55] offset:3072
    ds_write_b32 v10, v56 offset:4352
    s_waitcnt vmcnt(0) lgkmcnt(0)
    s_barrier
    s_lshl_b32 s54, s3, 2
    s_lshl_b32 s50, 1, s54
    s_cmp_eq_u32 s3, s30
    s_cselect_b32 s50, 0, s50
    s_cmp_eq_u32 s50, 0
    s_cbranch_scc1 L_pio1
    s_mov_b64 exec, 1
    buffer_load_dword v15, v9, s[16:19], 0 offen sc1
    s_mov_b64 exec, -1
L_pio1:
    ds_read_b32 v112, v11 offset:4096
    ds_read_b128 v[96:99], v6 offset:0
    ds_read_b128 v[100:103], v6 offset:1024
    ds_read_b32 v113, v11 offset:4352
    ds_read_b128 v[104:107], v6 offset:2048
    ds_read_b128 v[108:111], v6 offset:3072
    s_waitcnt lgkmcnt(3)
    v_add_f32 v112, v112, v72
    v_add_f32 v96, v96, v64
    v_add_f32 v97, v97, v65
    v_add_f32 v98, v98, v66
    v_add_f32 v99, v99, v67
    v_add_f32 v100, v100, v68
    v_add_f32 v101, v101, v69
    v_add_f32 v102, v102, v70
    v_add_f32 v103, v103, v71
    s_waitcnt lgkmcnt(0)
    v_add_f32 v113, v113, v88
    v_add_f32 v104, v104, v80
    v_add_f32 v105, v105, v81
    v_add_f32 v106, v106, v82
    v_add_f32 v107, v107, v83
    v_add_f32 v108, v108, v84
    v_add_f32 v109, v109, v85
    v_add_f32 v110, v110, v86
    v_add_f32 v111, v111, v87
    v_mov_b32 v16, v24
    v_mov_b32 v17, v25
    v_mov_b32 v18, v26
    v_mov_b32 v19, v27
    v_mov_b32 v20, v28
    v_mov_b32 v21, v29
    v_mov_b32 v22, v30
    v_mov_b32 v23, v31
L_final:
    v_rcp_f32 v114, v112
    v_cmp_lt_f32 s[58:59], s67, v112
    v_cmp_gt_f32 vcc, s68, v112
    s_nop 0
    s_and_b64 s[58:59], s[58:59], vcc
    v_mul_f32 v96, v96, v114
    v_mul_f32 v97, v97, v114
    v_mul_f32 v98, v98, v114
    v_mul_f32 v99, v99, v114
    v_mul_f32 v100, v100, v114
    v_mul_f32 v101, v101, v114
    v_mul_f32 v102, v102, v114
    v_mul_f32 v103, v103, v114
    v_cvt_pk_bf16_f32 v240, v96, v97
    v_cvt_pk_bf16_f32 v241, v98, v99
    v_cvt_pk_bf16_f32 v242, v100, v101
    v_cvt_pk_bf16_f32 v243, v102, v103
    v_add_f32 v116, |v96|, |v97|
    v_add_f32 v116, v116, |v98|
    v_add_f32 v116, v116, |v99|
    v_add_f32 v116, v116, |v100|
    v_add_f32 v116, v116, |v101|
    v_add_f32 v116, v116, |v102|
    v_add_f32 v116, v116, |v103|
    v_rcp_f32 v115, v113
    v_cmp_lt_f32 s[70:71], s67, v113
    v_cmp_gt_f32 vcc, s68, v113
    s_nop 0
    s_and_b64 s[70:71], s[70:71], vcc
    v_mul_f32 v104, v104, v115
    v_mul_f32 v105, v105, v115
    v_mul_f32 v106, v106, v115
    v_mul_f32 v107, v107, v115
    v_mul_f32 v108, v108, v115
    v_mul_f32 v109, v109, v115
    v_mul_f32 v110, v110, v115
    v_mul_f32 v111, v111, v115
    v_cvt_pk_bf16_f32 v244, v104, v105
    v_cvt_pk_bf16_f32 v245, v106, v107
    v_cvt_pk_bf16_f32 v246, v108, v109
    v_cvt_pk_bf16_f32 v247, v110, v111
    v_add_f32 v117, |v104|, |v105|
    v_add_f32 v117, v117, |v106|
    v_add_f32 v117, v117, |v107|
    v_add_f32 v117, v117, |v108|
    v_add_f32 v117, v117, |v109|
    v_add_f32 v117, v117, |v110|
    v_add_f32 v117, v117, |v111|
    v_add_f32 v116, v116, v117
    s_and_b64 s[58:59], s[58:59], s[70:71]
    s_mov_b32 s54, 0x7f800000
    v_cmp_gt_f32 vcc, s54, v116
    s_nop 0
    s_and_b64 s[58:59], s[58:59], vcc
    s_cmp_eq_u64 s[58:59], -1
    s_cselect_b32 s54, 1, 0
    s_or_b32 s54, s54, s37
    s_cbranch_scc0 L_fb
    s_lshr_b32 s54, s3, 2
    s_lshl_b32 s54, s54, 13
    s_add_u32 s54, s54, s65
    s_add_u32 s55, s54, 4096
    buffer_store_dwordx4 v[240:243], v2, s[16:19], s54 offen sc1
    buffer_store_dwordx4 v[244:247], v2, s[16:19], s55 offen sc1
    s_andn2_b32 s57, s31, 7
    s_and_b32 s66, s3, 4
    s_add_u32 s57, s57, s66
    s_lshl_b32 s57, s57, 14
    s_and_b32 s66, s3, 3
    s_lshl_b32 s66, s66, 12
    s_add_u32 s57, s57, s66
    s_add_u32 s57, s57, 8388608
    s_mov_b32 s35, 0
    s_mov_b32 s63, 0
    v_bfe_u32 v3, v0, 2, 2
    v_lshrrev_b32 v8, 5, v0
    v_lshl_add_u32 v3, v8, 2, v3
    v_lshlrev_b32 v11, 7, v3
    v_bfe_u32 v3, v0, 4, 1
    v_lshlrev_b32 v3, 1, v3
    v_bfe_u32 v10, v0, 1, 1
    v_or_b32 v3, v3, v10
    v_bfe_u32 v10, v0, 3, 1
    v_lshl_or_b32 v3, v10, 2, v3
    v_lshl_add_u32 v11, v3, 4, v11
    v_and_b32 v3, 1, v0
    v_lshl_add_u32 v11, v3, 3, v11
    s_lshr_b32 s66, s3, 2
    s_lshl_b32 s66, s66, 15
    s_add_u32 s66, s66, 4608
    v_add_u32 v11, s66, v11
    v_xor_b32 v7, 64, v11
    v_mov_b32 v208, 0
    v_mov_b32 v209, 0
    v_mov_b32 v210, 0
    v_mov_b32 v211, 0
    v_mov_b32 v212, 0
    v_mov_b32 v213, 0
    v_mov_b32 v214, 0
    v_mov_b32 v215, 0
    v_mov_b32 v216, 0
    v_mov_b32 v217, 0
    v_mov_b32 v218, 0
    v_mov_b32 v219, 0
    v_mov_b32 v220, 0
    v_mov_b32 v221, 0
    v_mov_b32 v222, 0
    v_mov_b32 v223, 0
    v_mov_b32 v224, 0
    v_mov_b32 v225, 0
    v_mov_b32 v226, 0
    v_mov_b32 v227, 0
    v_mov_b32 v228, 0
    v_mov_b32 v229, 0
    v_mov_b32 v230, 0
    v_mov_b32 v231, 0
    v_mov_b32 v232, 0
    v_mov_b32 v233, 0
    v_mov_b32 v234, 0
    v_mov_b32 v235, 0
    v_mov_b32 v236, 0
    v_mov_b32 v237, 0
    v_mov_b32 v238, 0
    v_mov_b32 v239, 0
    v_and_b32 v10, 31, v0
    v_lshlrev_b32 v10, 11, v10
    v_lshl_add_u32 v10, v8, 4, v10
    s_and_b32 s54, s3, 3
    s_lshl_b32 s56, s29, 2
    s_add_u32 s56, s56, s54
    s_lshl_b32 s56, s56, 16
    s_lshl_b32 s54, s28, 10
    s_add_u32 s56, s56, s54
    s_lshl_b32 s54, s30, 7
    s_add_u32 s56, s56, s54
    s_and_b32 s54, s3, 4
    s_lshl_b32 s54, s54, 4
    s_add_u32 s56, s56, s54
    v_mov_b32 v14, 1
    s_mov_b64 exec, 1
    s_waitcnt vmcnt(0)
    ds_add_rtn_u32 v13, v12, v14 offset:4132
    s_waitcnt lgkmcnt(0)
    v_readfirstlane_b32 s54, v13
    s_nop 0
    s_cmp_lg_u32 s54, 7
    s_cbranch_scc1 L_pubo
    buffer_store_dword v14, v12, s[16:19], s38 offen sc1
    s_lshl_b32 s54, s30, 2
    s_lshl_b32 s54, 1, s54
    v_mov_b32 v13, s54
    ds_or_b32 v12, v13 offset:4148
L_pubo:
    s_mov_b64 exec, -1
    s_cmp_eq_u32 s50, 0
    s_cbranch_scc1 L_pcoa
    v_readfirstlane_b32 s54, v15
    v_mov_b32 v14, s50
    s_cmp_lg_u32 s54, 1
    s_cbranch_scc1 L_pcoa
    s_mov_b64 exec, 1
    ds_or_b32 v12, v14 offset:4148
    s_mov_b64 exec, -1
    s_mov_b32 s50, 0
L_pcoa:
    ds_read_b32 v14, v12 offset:4148
    s_waitcnt lgkmcnt(0)
    v_readfirstlane_b32 s54, v14
    s_and_b32 s55, s3, 4
    s_lshl_b32 s55, s55, 2
    s_lshr_b32 s54, s54, s55
    s_cmp_ge_u32 s63, 0x40000
    s_cselect_b32 s54, -1, s54
    s_and_b32 s54, s54, 0x1111
    s_andn2_b32 s36, s54, s35
    s_or_b32 s35, s35, s36
    s_cmp_eq_u32 s50, 0
    s_cbranch_scc1 L_pioa
    s_mov_b64 exec, 1
    buffer_load_dword v15, v9, s[16:19], 0 offen sc1
    s_mov_b64 exec, -1
L_pioa:
    s_bitcmp0_b32 s36, 0
    s_cbranch_scc1 L_oia0
    s_add_u32 s54, s57, 0
    buffer_load_dwordx4 v[144:147], v2, s[16:19], s54 offen offset:0 sc1
    buffer_load_dwordx4 v[148:151], v2, s[16:19], s54 offen offset:1024 sc1
    buffer_load_dwordx4 v[152:155], v2, s[16:19], s54 offen offset:2048 sc1
    buffer_load_dwordx4 v[156:159], v2, s[16:19], s54 offen offset:3072 sc1
L_oia0:
    s_bitcmp0_b32 s36, 4
    s_cbranch_scc1 L_oia1
    s_add_u32 s54, s57, 16384
    buffer_load_dwordx4 v[160:163], v2, s[16:19], s54 offen offset:0 sc1
    buffer_load_dwordx4 v[164:167], v2, s[16:19], s54 offen offset:1024 sc1
    buffer_load_dwordx4 v[168:171], v2, s[16:19], s54 offen offset:2048 sc1
    buffer_load_dwordx4 v[172:175], v2, s[16:19], s54 offen offset:3072 sc1
L_oia1:
    s_bitcmp0_b32 s36, 8
    s_cbranch_scc1 L_oia2
    s_add_u32 s54, s57, 32768
    buffer_load_dwordx4 v[176:179], v2, s[16:19], s54 offen offset:0 sc1
    buffer_load_dwordx4 v[180:183], v2, s[16:19], s54 offen offset:1024 sc1
    buffer_load_dwordx4 v[184:187], v2, s[16:19], s54 offen offset:2048 sc1
    buffer_load_dwordx4 v[188:191], v2, s[16:19], s54 offen offset:3072 sc1
L_oia2:
    s_bitcmp0_b32 s36, 12
    s_cbranch_scc1 L_oia3
    s_add_u32 s54, s57, 49152
    buffer_load_dwordx4 v[192:195], v2, s[16:19], s54 offen offset:0 sc1
    buffer_load_dwordx4 v[196:199], v2, s[16:19], s54 offen offset:1024 sc1
    buffer_load_dwordx4 v[200:203], v2, s[16:19], s54 offen offset:2048 sc1
    buffer_load_dwordx4 v[204:207], v2, s[16:19], s54 offen offset:3072 sc1
L_oia3:
    ds_read_b64_tr_b16 v[16:17], v11 offset:0
    ds_read_b64_tr_b16 v[18:19], v11 offset:1024
    ds_read_b64_tr_b16 v[20:21], v7 offset:0
    ds_read_b64_tr_b16 v[22:23], v7 offset:1024
    ds_read_b64_tr_b16 v[24:25], v11 offset:2048
    ds_read_b64_tr_b16 v[26:27], v11 offset:3072
    ds_read_b64_tr_b16 v[28:29], v7 offset:2048
    ds_read_b64_tr_b16 v[30:31], v7 offset:3072
    ds_read_b64_tr_b16 v[32:33], v11 offset:4096
    ds_read_b64_tr_b16 v[34:35], v11 offset:5120
    ds_read_b64_tr_b16 v[36:37], v7 offset:4096
    ds_read_b64_tr_b16 v[38:39], v7 offset:5120
    ds_read_b64_tr_b16 v[40:41], v11 offset:6144
    ds_read_b64_tr_b16 v[42:43], v11 offset:7168
    ds_read_b64_tr_b16 v[44:45], v7 offset:6144
    ds_read_b64_tr_b16 v[46:47], v7 offset:7168
    ds_read_b64_tr_b16 v[48:49], v11 offset:8192
    ds_read_b64_tr_b16 v[50:51], v11 offset:9216
    ds_read_b64_tr_b16 v[52:53], v7 offset:8192
    ds_read_b64_tr_b16 v[54:55], v7 offset:9216
    ds_read_b64_tr_b16 v[56:57], v11 offset:10240
    ds_read_b64_tr_b16 v[58:59], v11 offset:11264
    ds_read_b64_tr_b16 v[60:61], v7 offset:10240
    ds_read_b64_tr_b16 v[62:63], v7 offset:11264
    ds_read_b64_tr_b16 v[64:65], v11 offset:12288
    ds_read_b64_tr_b16 v[66:67], v11 offset:13312
    ds_read_b64_tr_b16 v[68:69], v7 offset:12288
    ds_read_b64_tr_b16 v[70:71], v7 offset:13312
    ds_read_b64_tr_b16 v[72:73], v11 offset:14336
    ds_read_b64_tr_b16 v[74:75], v11 offset:15360
    ds_read_b64_tr_b16 v[76:77], v7 offset:14336
    ds_read_b64_tr_b16 v[78:79], v7 offset:15360
    ds_read_b64_tr_b16 v[80:81], v11 offset:16384
    ds_read_b64_tr_b16 v[82:83], v11 offset:17408
    ds_read_b64_tr_b16 v[84:85], v7 offset:16384
    ds_read_b64_tr_b16 v[86:87], v7 offset:17408
    ds_read_b64_tr_b16 v[88:89], v11 offset:18432
    ds_read_b64_tr_b16 v[90:91], v11 offset:19456
    ds_read_b64_tr_b16 v[92:93], v7 offset:18432
    ds_read_b64_tr_b16 v[94:95], v7 offset:19456
    ds_read_b64_tr_b16 v[96:97], v11 offset:20480
    ds_read_b64_tr_b16 v[98:99], v11 offset:21504
    ds_read_b64_tr_b16 v[100:101], v7 offset:20480
    ds_read_b64_tr_b16 v[102:103], v7 offset:21504
    ds_read_b64_tr_b16 v[104:105], v11 offset:22528
    ds_read_b64_tr_b16 v[106:107], v11 offset:23552
    ds_read_b64_tr_b16 v[108:109], v7 offset:22528
    ds_read_b64_tr_b16 v[110:111], v7 offset:23552
    ds_read_b64_tr_b16 v[112:113], v11 offset:24576
    ds_read_b64_tr_b16 v[114:115], v11 offset:25600
    ds_read_b64_tr_b16 v[116:117], v7 offset:24576
    ds_read_b64_tr_b16 v[118:119], v7 offset:25600
    ds_read_b64_tr_b16 v[120:121], v11 offset:26624
    ds_read_b64_tr_b16 v[122:123], v11 offset:27648
    ds_read_b64_tr_b16 v[124:125], v7 offset:26624
    ds_read_b64_tr_b16 v[126:127], v7 offset:27648
    ds_read_b64_tr_b16 v[128:129], v11 offset:28672
    ds_read_b64_tr_b16 v[130:131], v11 offset:29696
    ds_read_b64_tr_b16 v[132:133], v7 offset:28672
    ds_read_b64_tr_b16 v[134:135], v7 offset:29696
    ds_read_b64_tr_b16 v[136:137], v11 offset:30720
    ds_read_b64_tr_b16 v[138:139], v11 offset:31744
    ds_read_b64_tr_b16 v[140:141], v7 offset:30720
    ds_read_b64_tr_b16 v[142:143], v7 offset:31744
    s_waitcnt lgkmcnt(0)
L_p3l:
    s_mov_b32 s42, s36
    s_mov_b32 s43, 0
    s_mov_b32 s36, 0
    s_cmp_eq_u32 s35, 0x1111
    s_cbranch_scc1 L_p3m
    s_add_u32 s63, s63, 1
    s_bcnt1_i32_b32 s55, s42
    s_cmp_eq_u32 s50, 0
    s_cbranch_scc1 L_pcob
    s_cmp_ge_u32 s55, 3
    s_cbranch_scc1 L_wcp_3
    s_cmp_ge_u32 s55, 2
    s_cbranch_scc1 L_wcp_2
    s_cmp_ge_u32 s55, 1
    s_cbranch_scc1 L_wcp_1
    s_waitcnt vmcnt(0)
L_wcp_1:
    s_waitcnt vmcnt(4)
L_wcp_2:
    s_waitcnt vmcnt(8)
L_wcp_3:
    s_waitcnt vmcnt(12)
    v_readfirstlane_b32 s54, v15
    v_mov_b32 v14, s50
    s_cmp_lg_u32 s54, 1
    s_cbranch_scc1 L_pcob
    s_mov_b64 exec, 1
    ds_or_b32 v12, v14 offset:4148
    s_mov_b64 exec, -1
    s_mov_b32 s50, 0
L_pcob:
    ds_read_b32 v14, v12 offset:4148
    s_waitcnt lgkmcnt(0)
    v_readfirstlane_b32 s54, v14
    s_and_b32 s55, s3, 4
    s_lshl_b32 s55, s55, 2
    s_lshr_b32 s54, s54, s55
    s_cmp_ge_u32 s63, 0x40000
    s_cselect_b32 s54, -1, s54
    s_and_b32 s54, s54, 0x1111
    s_andn2_b32 s36, s54, s35
    s_or_b32 s35, s35, s36
    s_or_b32 s54, s36, s42
    s_cbranch_scc1 L_oibs
    s_sleep 2
L_oibs:
    s_cmp_eq_u32 s50, 0
    s_cbranch_scc1 L_piob
    s_mov_b64 exec, 1
    buffer_load_dword v15, v9, s[16:19], 0 offen sc1
    s_mov_b64 exec, -1
L_piob:
    s_bitcmp0_b32 s36, 0
    s_cbranch_scc1 L_oib0
    s_add_u32 s54, s57, 0
    buffer_load_dwordx4 v[144:147], v2, s[16:19], s54 offen offset:0 sc1
    buffer_load_dwordx4 v[148:151], v2, s[16:19], s54 offen offset:1024 sc1
    buffer_load_dwordx4 v[152:155], v2, s[16:19], s54 offen offset:2048 sc1
    buffer_load_dwordx4 v[156:159], v2, s[16:19], s54 offen offset:3072 sc1
L_oib0:
    s_bitcmp0_b32 s36, 4
    s_cbranch_scc1 L_oib1
    s_add_u32 s54, s57, 16384
    buffer_load_dwordx4 v[160:163], v2, s[16:19], s54 offen offset:0 sc1
    buffer_load_dwordx4 v[164:167], v2, s[16:19], s54 offen offset:1024 sc1
    buffer_load_dwordx4 v[168:171], v2, s[16:19], s54 offen offset:2048 sc1
    buffer_load_dwordx4 v[172:175], v2, s[16:19], s54 offen offset:3072 sc1
L_oib1:
    s_bitcmp0_b32 s36, 8
    s_cbranch_scc1 L_oib2
    s_add_u32 s54, s57, 32768
    buffer_load_dwordx4 v[176:179], v2, s[16:19], s54 offen offset:0 sc1
    buffer_load_dwordx4 v[180:183], v2, s[16:19], s54 offen offset:1024 sc1
    buffer_load_dwordx4 v[184:187], v2, s[16:19], s54 offen offset:2048 sc1
    buffer_load_dwordx4 v[188:191], v2, s[16:19], s54 offen offset:3072 sc1
L_oib2:
    s_bitcmp0_b32 s36, 12
    s_cbranch_scc1 L_oib3
    s_add_u32 s54, s57, 49152
    buffer_load_dwordx4 v[192:195], v2, s[16:19], s54 offen offset:0 sc1
    buffer_load_dwordx4 v[196:199], v2, s[16:19], s54 offen offset:1024 sc1
    buffer_load_dwordx4 v[200:203], v2, s[16:19], s54 offen offset:2048 sc1
    buffer_load_dwordx4 v[204:207], v2, s[16:19], s54 offen offset:3072 sc1
L_oib3:
    s_bcnt1_i32_b32 s43, s36
L_p3m:
    s_bitcmp0_b32 s42, 0
    s_cbranch_scc1 L_om0
    s_lshr_b32 s54, s42, 4
    s_bcnt1_i32_b32 s55, s54
    s_add_u32 s55, s55, s43
    s_cmp_ge_u32 s55, 3
    s_cbranch_scc1 L_wcm0_3
    s_cmp_ge_u32 s55, 2
    s_cbranch_scc1 L_wcm0_2
    s_cmp_ge_u32 s55, 1
    s_cbranch_scc1 L_wcm0_1
    s_waitcnt vmcnt(0)
L_wcm0_1:
    s_waitcnt vmcnt(4)
L_wcm0_2:
    s_waitcnt vmcnt(8)
L_wcm0_3:
    s_waitcnt vmcnt(12)
    v_mfma_f32_32x32x16_bf16 v[208:223], v[16:19], v[144:147], v[208:223]
    v_mfma_f32_32x32x16_bf16 v[224:239], v[20:23], v[144:147], v[224:239]
    v_mfma_f32_32x32x16_bf16 v[208:223], v[24:27], v[148:151], v[208:223]
    v_mfma_f32_32x32x16_bf16 v[224:239], v[28:31], v[148:151], v[224:239]
    v_mfma_f32_32x32x16_bf16 v[208:223], v[32:35], v[152:155], v[208:223]
    v_mfma_f32_32x32x16_bf16 v[224:239], v[36:39], v[152:155], v[224:239]
    v_mfma_f32_32x32x16_bf16 v[208:223], v[40:43], v[156:159], v[208:223]
    v_mfma_f32_32x32x16_bf16 v[224:239], v[44:47], v[156:159], v[224:239]
L_om0:
    s_bitcmp0_b32 s42, 4
    s_cbranch_scc1 L_om1
    s_lshr_b32 s54, s42, 8
    s_bcnt1_i32_b32 s55, s54
    s_add_u32 s55, s55, s43
    s_cmp_ge_u32 s55, 3
    s_cbranch_scc1 L_wcm1_3
    s_cmp_ge_u32 s55, 2
    s_cbranch_scc1 L_wcm1_2
    s_cmp_ge_u32 s55, 1
    s_cbranch_scc1 L_wcm1_1
    s_waitcnt vmcnt(0)
L_wcm1_1:
    s_waitcnt vmcnt(4)
L_wcm1_2:
    s_waitcnt vmcnt(8)
L_wcm1_3:
    s_waitcnt vmcnt(12)
    v_mfma_f32_32x32x16_bf16 v[208:223], v[48:51], v[160:163], v[208:223]
    v_mfma_f32_32x32x16_bf16 v[224:239], v[52:55], v[160:163], v[224:239]
    v_mfma_f32_32x32x16_bf16 v[208:223], v[56:59], v[164:167], v[208:223]
    v_mfma_f32_32x32x16_bf16 v[224:239], v[60:63], v[164:167], v[224:239]
    v_mfma_f32_32x32x16_bf16 v[208:223], v[64:67], v[168:171], v[208:223]
    v_mfma_f32_32x32x16_bf16 v[224:239], v[68:71], v[168:171], v[224:239]
    v_mfma_f32_32x32x16_bf16 v[208:223], v[72:75], v[172:175], v[208:223]
    v_mfma_f32_32x32x16_bf16 v[224:239], v[76:79], v[172:175], v[224:239]
L_om1:
    s_bitcmp0_b32 s42, 8
    s_cbranch_scc1 L_om2
    s_lshr_b32 s54, s42, 12
    s_bcnt1_i32_b32 s55, s54
    s_add_u32 s55, s55, s43
    s_cmp_ge_u32 s55, 3
    s_cbranch_scc1 L_wcm2_3
    s_cmp_ge_u32 s55, 2
    s_cbranch_scc1 L_wcm2_2
    s_cmp_ge_u32 s55, 1
    s_cbranch_scc1 L_wcm2_1
    s_waitcnt vmcnt(0)
L_wcm2_1:
    s_waitcnt vmcnt(4)
L_wcm2_2:
    s_waitcnt vmcnt(8)
L_wcm2_3:
    s_waitcnt vmcnt(12)
    v_mfma_f32_32x32x16_bf16 v[208:223], v[80:83], v[176:179], v[208:223]
    v_mfma_f32_32x32x16_bf16 v[224:239], v[84:87], v[176:179], v[224:239]
    v_mfma_f32_32x32x16_bf16 v[208:223], v[88:91], v[180:183], v[208:223]
    v_mfma_f32_32x32x16_bf16 v[224:239], v[92:95], v[180:183], v[224:239]
    v_mfma_f32_32x32x16_bf16 v[208:223], v[96:99], v[184:187], v[208:223]
    v_mfma_f32_32x32x16_bf16 v[224:239], v[100:103], v[184:187], v[224:239]
    v_mfma_f32_32x32x16_bf16 v[208:223], v[104:107], v[188:191], v[208:223]
    v_mfma_f32_32x32x16_bf16 v[224:239], v[108:111], v[188:191], v[224:239]
L_om2:
    s_bitcmp0_b32 s42, 12
    s_cbranch_scc1 L_om3
    s_lshr_b32 s54, s42, 16
    s_bcnt1_i32_b32 s55, s54
    s_add_u32 s55, s55, s43
    s_cmp_ge_u32 s55, 3
    s_cbranch_scc1 L_wcm3_3
    s_cmp_ge_u32 s55, 2
    s_cbranch_scc1 L_wcm3_2
    s_cmp_ge_u32 s55, 1
    s_cbranch_scc1 L_wcm3_1
    s_waitcnt vmcnt(0)
L_wcm3_1:
    s_waitcnt vmcnt(4)
L_wcm3_2:
    s_waitcnt vmcnt(8)
L_wcm3_3:
    s_waitcnt vmcnt(12)
    v_mfma_f32_32x32x16_bf16 v[208:223], v[112:115], v[192:195], v[208:223]
    v_mfma_f32_32x32x16_bf16 v[224:239], v[116:119], v[192:195], v[224:239]
    v_mfma_f32_32x32x16_bf16 v[208:223], v[120:123], v[196:199], v[208:223]
    v_mfma_f32_32x32x16_bf16 v[224:239], v[124:127], v[196:199], v[224:239]
    v_mfma_f32_32x32x16_bf16 v[208:223], v[128:131], v[200:203], v[208:223]
    v_mfma_f32_32x32x16_bf16 v[224:239], v[132:135], v[200:203], v[224:239]
    v_mfma_f32_32x32x16_bf16 v[208:223], v[136:139], v[204:207], v[208:223]
    v_mfma_f32_32x32x16_bf16 v[224:239], v[140:143], v[204:207], v[224:239]
L_om3:
    s_cmp_lg_u32 s35, 0x1111
    s_cbranch_scc1 L_p3l
    s_cmp_lg_u32 s36, 0
    s_cbranch_scc1 L_p3l
    s_lshr_b32 s55, s3, 2
    s_nop 7
    s_nop 3
    s_cmp_lg_u32 s55, 0
    s_cbranch_scc1 L_x1
    ds_write_b128 v6, v[224:227] offset:0
    ds_write_b128 v6, v[228:231] offset:1024
    ds_write_b128 v6, v[232:235] offset:2048
    ds_write_b128 v6, v[236:239] offset:3072
    s_waitcnt lgkmcnt(0)
    s_barrier
    ds_read_b128 v[16:19], v5 offset:0
    ds_read_b128 v[20:23], v5 offset:1024
    ds_read_b128 v[24:27], v5 offset:2048
    ds_read_b128 v[28:31], v5 offset:3072
    s_waitcnt lgkmcnt(3)
    v_add_f32 v208, v208, v16
    v_add_f32 v209, v209, v17
    v_add_f32 v210, v210, v18
    v_add_f32 v211, v211, v19
    v_cvt_pk_bf16_f32 v32, v208, v209
    v_cvt_pk_bf16_f32 v33, v210, v211
    s_waitcnt lgkmcnt(2)
    v_add_f32 v212, v212, v20
    v_add_f32 v213, v213, v21
    v_add_f32 v214, v214, v22
    v_add_f32 v215, v215, v23
    v_cvt_pk_bf16_f32 v34, v212, v213
    v_cvt_pk_bf16_f32 v35, v214, v215
    s_waitcnt lgkmcnt(1)
    v_add_f32 v216, v216, v24
    v_add_f32 v217, v217, v25
    v_add_f32 v218, v218, v26
    v_add_f32 v219, v219, v27
    v_cvt_pk_bf16_f32 v36, v216, v217
    v_cvt_pk_bf16_f32 v37, v218, v219
    s_waitcnt lgkmcnt(0)
    v_add_f32 v220, v220, v28
    v_add_f32 v221, v221, v29
    v_add_f32 v222, v222, v30
    v_add_f32 v223, v223, v31
    v_cvt_pk_bf16_f32 v38, v220, v221
    v_cvt_pk_bf16_f32 v39, v222, v223
    s_branch L_x2
L_x1:
    ds_write_b128 v6, v[208:211] offset:0
    ds_write_b128 v6, v[212:215] offset:1024
    ds_write_b128 v6, v[216:219] offset:2048
    ds_write_b128 v6, v[220:223] offset:3072
    s_waitcnt lgkmcnt(0)
    s_barrier
    ds_read_b128 v[16:19], v5 offset:0
    ds_read_b128 v[20:23], v5 offset:1024
    ds_read_b128 v[24:27], v5 offset:2048
    ds_read_b128 v[28:31], v5 offset:3072
    s_waitcnt lgkmcnt(3)
    v_add_f32 v224, v224, v16
    v_add_f32 v225, v225, v17
    v_add_f32 v226, v226, v18
    v_add_f32 v227, v227, v19
    v_cvt_pk_bf16_f32 v32, v224, v225
    v_cvt_pk_bf16_f32 v33, v226, v227
    s_waitcnt lgkmcnt(2)
    v_add_f32 v228, v228, v20
    v_add_f32 v229, v229, v21
    v_add_f32 v230, v230, v22
    v_add_f32 v231, v231, v23
    v_cvt_pk_bf16_f32 v34, v228, v229
    v_cvt_pk_bf16_f32 v35, v230, v231
    s_waitcnt lgkmcnt(1)
    v_add_f32 v232, v232, v24
    v_add_f32 v233, v233, v25
    v_add_f32 v234, v234, v26
    v_add_f32 v235, v235, v27
    v_cvt_pk_bf16_f32 v36, v232, v233
    v_cvt_pk_bf16_f32 v37, v234, v235
    s_waitcnt lgkmcnt(0)
    v_add_f32 v236, v236, v28
    v_add_f32 v237, v237, v29
    v_add_f32 v238, v238, v30
    v_add_f32 v239, v239, v31
    v_cvt_pk_bf16_f32 v38, v236, v237
    v_cvt_pk_bf16_f32 v39, v238, v239
L_x2:
    s_nop 1
    v_permlane32_swap_b32 v32, v34
    v_permlane32_swap_b32 v33, v35
    buffer_store_dwordx4 v[32:35], v10, s[20:23], s56 offen offset:0
    v_permlane32_swap_b32 v36, v38
    v_permlane32_swap_b32 v37, v39
    buffer_store_dwordx4 v[36:39], v10, s[20:23], s56 offen offset:32
L_end:
    s_endpgm
L_fb:
    ds_read_b128 v[128:131], v2 offset:0
    ds_read_b128 v[132:135], v2 offset:1024
    ds_read_b128 v[136:139], v2 offset:2048
    ds_read_b128 v[140:143], v2 offset:3072
    s_mov_b32 s37, 1
    s_lshr_b32 s44, s3, 2
    s_lshl_b32 s44, s44, 1
    s_lshl_b32 s54, s29, 2
    s_add_u32 s44, s44, s54
    s_max_u32 s43, s44, 8
    s_sub_u32 s43, s43, 8
    v_mov_b32 v248, 0xff800000
    v_mov_b32 v249, 0xff800000
    v_mov_b32 v32, 0
    v_mov_b32 v33, 0
    v_mov_b32 v34, 0
    v_mov_b32 v35, 0
    v_mov_b32 v36, 0
    v_mov_b32 v37, 0
    v_mov_b32 v38, 0
    v_mov_b32 v39, 0
    v_mov_b32 v40, 0
    v_mov_b32 v41, 0
    v_mov_b32 v42, 0
    v_mov_b32 v43, 0
    v_mov_b32 v44, 0
    v_mov_b32 v45, 0
    v_mov_b32 v46, 0
    v_mov_b32 v47, 0
    v_mov_b32 v48, 0
    v_mov_b32 v49, 0
    v_mov_b32 v50, 0
    v_mov_b32 v51, 0
    v_mov_b32 v52, 0
    v_mov_b32 v53, 0
    v_mov_b32 v54, 0
    v_mov_b32 v55, 0
    v_mov_b32 v56, 0
    v_mov_b32 v57, 0
    v_mov_b32 v58, 0
    v_mov_b32 v59, 0
    v_mov_b32 v60, 0
    v_mov_b32 v61, 0
    v_mov_b32 v62, 0
    v_mov_b32 v63, 0
    s_waitcnt lgkmcnt(0)
    s_mov_b32 s42, s43
L_fbl0:
    s_lshr_b32 s54, s42, 2
    s_sub_u32 s54, s54, s29
    s_add_u32 s54, s54, 2
    s_lshl_b32 s54, s54, 18
    s_add_u32 s47, s34, s54
    s_and_b32 s54, s42, 3
    s_lshl_b32 s54, s54, 10
    s_add_u32 s47, s47, s54
    buffer_load_dwordx4 v[144:147], v2, s[16:19], s47 offen sc1
    s_mov_b64 exec, s[60:61]
    buffer_load_dwordx4 v[168:171], v3, s[16:19], s47 offen sc1
    buffer_load_dwordx4 v[172:175], v3, s[16:19], s47 offen offset:512 sc1
    s_mov_b64 exec, -1
    s_waitcnt vmcnt(0)
    s_sub_u32 s54, s44, s42
    s_add_u32 s54, s54, 0
    s_cmp_eq_u32 s54, 0
    s_cselect_b32 s45, 1.0, 0
    s_cmp_eq_u32 s54, 8
    s_cselect_b32 s45, -1.0, s45
    s_cmp_ge_u32 s54, 8
    s_cselect_b32 s46, 4048155338, 0
    v_mov_b32 v14, s46
    v_fma_f32 v80, v128, s45, v14
    v_fma_f32 v81, v129, s45, v14
    v_fma_f32 v82, v130, s45, v14
    v_fma_f32 v83, v131, s45, v14
    v_fma_f32 v84, v132, s45, v14
    v_fma_f32 v85, v133, s45, v14
    v_fma_f32 v86, v134, s45, v14
    v_fma_f32 v87, v135, s45, v14
    v_fma_f32 v88, v136, s45, v14
    v_fma_f32 v89, v137, s45, v14
    v_fma_f32 v90, v138, s45, v14
    v_fma_f32 v91, v139, s45, v14
    v_fma_f32 v92, v140, s45, v14
    v_fma_f32 v93, v141, s45, v14
    v_fma_f32 v94, v142, s45, v14
    v_fma_f32 v95, v143, s45, v14
    s_nop 1
    v_mfma_f32_32x32x16_bf16 v[64:79], v[144:147], v[16:19], v[80:95]
    s_nop 11
    v_max3_f32 v248, v64, v65, v248
    v_max3_f32 v248, v66, v67, v248
    v_max3_f32 v248, v68, v69, v248
    v_max3_f32 v248, v70, v71, v248
    v_max3_f32 v248, v72, v73, v248
    v_max3_f32 v248, v74, v75, v248
    v_max3_f32 v248, v76, v77, v248
    v_max3_f32 v248, v78, v79, v248
    s_sub_u32 s54, s44, s42
    s_add_u32 s54, s54, 1
    s_cmp_eq_u32 s54, 0
    s_cselect_b32 s45, 1.0, 0
    s_cmp_eq_u32 s54, 8
    s_cselect_b32 s45, -1.0, s45
    s_cmp_ge_u32 s54, 8
    s_cselect_b32 s46, 4048155338, 0
    v_mov_b32 v14, s46
    v_fma_f32 v80, v128, s45, v14
    v_fma_f32 v81, v129, s45, v14
    v_fma_f32 v82, v130, s45, v14
    v_fma_f32 v83, v131, s45, v14
    v_fma_f32 v84, v132, s45, v14
    v_fma_f32 v85, v133, s45, v14
    v_fma_f32 v86, v134, s45, v14
    v_fma_f32 v87, v135, s45, v14
    v_fma_f32 v88, v136, s45, v14
    v_fma_f32 v89, v137, s45, v14
    v_fma_f32 v90, v138, s45, v14
    v_fma_f32 v91, v139, s45, v14
    v_fma_f32 v92, v140, s45, v14
    v_fma_f32 v93, v141, s45, v14
    v_fma_f32 v94, v142, s45, v14
    v_fma_f32 v95, v143, s45, v14
    s_nop 1
    v_mfma_f32_32x32x16_bf16 v[64:79], v[144:147], v[20:23], v[80:95]
    s_nop 11
    v_max3_f32 v249, v64, v65, v249
    v_max3_f32 v249, v66, v67, v249
    v_max3_f32 v249, v68, v69, v249
    v_max3_f32 v249, v70, v71, v249
    v_max3_f32 v249, v72, v73, v249
    v_max3_f32 v249, v74, v75, v249
    v_max3_f32 v249, v76, v77, v249
    v_max3_f32 v249, v78, v79, v249
    s_add_u32 s42, s42, 1
    s_add_u32 s54, s44, 1
    s_cmp_le_u32 s42, s54
    s_cbranch_scc1 L_fbl0
    v_mov_b32 v14, v248
    s_nop 1
    v_permlane32_swap_b32 v248, v14
    v_max_f32 v248, v248, v14
    v_mov_b32 v14, v249
    s_nop 1
    v_permlane32_swap_b32 v249, v14
    v_max_f32 v249, v249, v14
    s_mov_b32 s42, s43
L_fbl1:
    s_lshr_b32 s54, s42, 2
    s_sub_u32 s54, s54, s29
    s_add_u32 s54, s54, 2
    s_lshl_b32 s54, s54, 18
    s_add_u32 s47, s34, s54
    s_and_b32 s54, s42, 3
    s_lshl_b32 s54, s54, 10
    s_add_u32 s47, s47, s54
    buffer_load_dwordx4 v[144:147], v2, s[16:19], s47 offen sc1
    s_mov_b64 exec, s[60:61]
    buffer_load_dwordx4 v[168:171], v3, s[16:19], s47 offen sc1
    buffer_load_dwordx4 v[172:175], v3, s[16:19], s47 offen offset:512 sc1
    s_mov_b64 exec, -1
    s_waitcnt vmcnt(0)
    s_sub_u32 s54, s44, s42
    s_add_u32 s54, s54, 0
    s_cmp_eq_u32 s54, 0
    s_cselect_b32 s45, 1.0, 0
    s_cmp_eq_u32 s54, 8
    s_cselect_b32 s45, -1.0, s45
    s_cmp_ge_u32 s54, 8
    s_cselect_b32 s46, 4048155338, 0
    v_mov_b32 v14, s46
    v_fma_f32 v80, v128, s45, v14
    v_fma_f32 v81, v129, s45, v14
    v_fma_f32 v82, v130, s45, v14
    v_fma_f32 v83, v131, s45, v14
    v_fma_f32 v84, v132, s45, v14
    v_fma_f32 v85, v133, s45, v14
    v_fma_f32 v86, v134, s45, v14
    v_fma_f32 v87, v135, s45, v14
    v_fma_f32 v88, v136, s45, v14
    v_fma_f32 v89, v137, s45, v14
    v_fma_f32 v90, v138, s45, v14
    v_fma_f32 v91, v139, s45, v14
    v_fma_f32 v92, v140, s45, v14
    v_fma_f32 v93, v141, s45, v14
    v_fma_f32 v94, v142, s45, v14
    v_fma_f32 v95, v143, s45, v14
    v_sub_f32 v80, v80, v248
    v_sub_f32 v81, v81, v248
    v_sub_f32 v82, v82, v248
    v_sub_f32 v83, v83, v248
    v_sub_f32 v84, v84, v248
    v_sub_f32 v85, v85, v248
    v_sub_f32 v86, v86, v248
    v_sub_f32 v87, v87, v248
    v_sub_f32 v88, v88, v248
    v_sub_f32 v89, v89, v248
    v_sub_f32 v90, v90, v248
    v_sub_f32 v91, v91, v248
    v_sub_f32 v92, v92, v248
    v_sub_f32 v93, v93, v248
    v_sub_f32 v94, v94, v248
    v_sub_f32 v95, v95, v248
    s_nop 1
    v_mfma_f32_32x32x16_bf16 v[64:79], v[144:147], v[16:19], v[80:95]
    s_nop 11
    v_exp_f32 v64, v64
    v_exp_f32 v65, v65
    v_exp_f32 v66, v66
    v_exp_f32 v67, v67
    v_exp_f32 v68, v68
    v_exp_f32 v69, v69
    v_exp_f32 v70, v70
    v_exp_f32 v71, v71
    v_exp_f32 v72, v72
    v_exp_f32 v73, v73
    v_exp_f32 v74, v74
    v_exp_f32 v75, v75
    v_exp_f32 v76, v76
    v_exp_f32 v77, v77
    v_exp_f32 v78, v78
    v_exp_f32 v79, v79
    v_cvt_pk_bf16_f32 v64, v64, v65
    v_cvt_pk_bf16_f32 v65, v66, v67
    v_cvt_pk_bf16_f32 v66, v68, v69
    v_cvt_pk_bf16_f32 v67, v70, v71
    v_cvt_pk_bf16_f32 v72, v72, v73
    v_cvt_pk_bf16_f32 v73, v74, v75
    v_cvt_pk_bf16_f32 v74, v76, v77
    v_cvt_pk_bf16_f32 v75, v78, v79
    v_mfma_f32_32x32x16_bf16 v[32:47], v[168:171], v[64:67], v[32:47]
    s_nop 0
    v_mfma_f32_32x32x16_bf16 v[32:47], v[172:175], v[72:75], v[32:47]
    s_nop 7
    s_sub_u32 s54, s44, s42
    s_add_u32 s54, s54, 1
    s_cmp_eq_u32 s54, 0
    s_cselect_b32 s45, 1.0, 0
    s_cmp_eq_u32 s54, 8
    s_cselect_b32 s45, -1.0, s45
    s_cmp_ge_u32 s54, 8
    s_cselect_b32 s46, 4048155338, 0
    v_mov_b32 v14, s46
    v_fma_f32 v80, v128, s45, v14
    v_fma_f32 v81, v129, s45, v14
    v_fma_f32 v82, v130, s45, v14
    v_fma_f32 v83, v131, s45, v14
    v_fma_f32 v84, v132, s45, v14
    v_fma_f32 v85, v133, s45, v14
    v_fma_f32 v86, v134, s45, v14
    v_fma_f32 v87, v135, s45, v14
    v_fma_f32 v88, v136, s45, v14
    v_fma_f32 v89, v137, s45, v14
    v_fma_f32 v90, v138, s45, v14
    v_fma_f32 v91, v139, s45, v14
    v_fma_f32 v92, v140, s45, v14
    v_fma_f32 v93, v141, s45, v14
    v_fma_f32 v94, v142, s45, v14
    v_fma_f32 v95, v143, s45, v14
    v_sub_f32 v80, v80, v249
    v_sub_f32 v81, v81, v249
    v_sub_f32 v82, v82, v249
    v_sub_f32 v83, v83, v249
    v_sub_f32 v84, v84, v249
    v_sub_f32 v85, v85, v249
    v_sub_f32 v86, v86, v249
    v_sub_f32 v87, v87, v249
    v_sub_f32 v88, v88, v249
    v_sub_f32 v89, v89, v249
    v_sub_f32 v90, v90, v249
    v_sub_f32 v91, v91, v249
    v_sub_f32 v92, v92, v249
    v_sub_f32 v93, v93, v249
    v_sub_f32 v94, v94, v249
    v_sub_f32 v95, v95, v249
    s_nop 1
    v_mfma_f32_32x32x16_bf16 v[64:79], v[144:147], v[20:23], v[80:95]
    s_nop 11
    v_exp_f32 v64, v64
    v_exp_f32 v65, v65
    v_exp_f32 v66, v66
    v_exp_f32 v67, v67
    v_exp_f32 v68, v68
    v_exp_f32 v69, v69
    v_exp_f32 v70, v70
    v_exp_f32 v71, v71
    v_exp_f32 v72, v72
    v_exp_f32 v73, v73
    v_exp_f32 v74, v74
    v_exp_f32 v75, v75
    v_exp_f32 v76, v76
    v_exp_f32 v77, v77
    v_exp_f32 v78, v78
    v_exp_f32 v79, v79
    v_cvt_pk_bf16_f32 v64, v64, v65
    v_cvt_pk_bf16_f32 v65, v66, v67
    v_cvt_pk_bf16_f32 v66, v68, v69
    v_cvt_pk_bf16_f32 v67, v70, v71
    v_cvt_pk_bf16_f32 v72, v72, v73
    v_cvt_pk_bf16_f32 v73, v74, v75
    v_cvt_pk_bf16_f32 v74, v76, v77
    v_cvt_pk_bf16_f32 v75, v78, v79
    v_mfma_f32_32x32x16_bf16 v[48:63], v[168:171], v[64:67], v[48:63]
    s_nop 0
    v_mfma_f32_32x32x16_bf16 v[48:63], v[172:175], v[72:75], v[48:63]
    s_nop 7
    s_add_u32 s42, s42, 1
    s_add_u32 s54, s44, 1
    s_cmp_le_u32 s42, s54
    s_cbranch_scc1 L_fbl1
    s_nop 7
    v_mov_b32 v96, v32
    v_mov_b32 v97, v33
    v_mov_b32 v98, v34
    v_mov_b32 v99, v35
    v_mov_b32 v100, v36
    v_mov_b32 v101, v37
    v_mov_b32 v102, v38
    v_mov_b32 v103, v39
    v_mov_b32 v112, v40
    v_mov_b32 v104, v48
    v_mov_b32 v105, v49
    v_mov_b32 v106, v50
    v_mov_b32 v107, v51
    v_mov_b32 v108, v52
    v_mov_b32 v109, v53
    v_mov_b32 v110, v54
    v_mov_b32 v111, v55
    v_mov_b32 v113, v56
    s_branch L_final
.section .rodata,"a"
.p2align 6
.amdhsa_kernel concat_heads__sliding_block__sliding_block__prompt_kernel
  .amdhsa_next_free_vgpr 256
  .amdhsa_next_free_sgpr 102
  .amdhsa_accum_offset 256
  .amdhsa_group_segment_fixed_size 0
  .amdhsa_kernarg_size 72
  .amdhsa_user_sgpr_count 2
  .amdhsa_user_sgpr_kernarg_segment_ptr 1
  .amdhsa_system_sgpr_workgroup_id_x 1
.end_amdhsa_kernel
```
